```python
import torch

def _softmax(x, axis=-1):
    return torch.softmax(x, dim=axis)
def _gelu(x):
    return torch.nn.functional.gelu(x, approximate="tanh")
def _silu(x):
    return torch.nn.functional.silu(x)
def _sigmoid(x):
    return torch.sigmoid(x)
def _layernorm(x, axis=-1, eps=1e-5):
    m = x.mean(dim=axis, keepdim=True)
    v = x.var(dim=axis, keepdim=True, unbiased=False)
    return (x - m) / torch.sqrt(v + eps)
def _scatter_add(tgt, idx, src, axis=0):
    return tgt.clone().index_add_(axis, idx, src)
def _segment_sum(src, seg, n):
    out = torch.zeros((n,) + src.shape[1:], dtype=src.dtype)
    return out.index_add_(0, seg, src)
def _pad(x, pw):
    flat = tuple(v for pair in reversed(pw) for v in pair)
    return torch.nn.functional.pad(x, flat)

kernel_name = 'parallel_sum__gqa_block_cached__swiglu_ffn__decode'

def setup_inputs():

    _w = (lambda a: (lambda t: t.to(torch.bfloat16) if t.is_floating_point() else t)(torch.as_tensor(a)))
    def _A_setup():
        B, Sq, D = 2, 1, 576
        Hq, Hkv, Sk, Dh = 32, 16, 32768, 128
        assert Hq % Hkv == 0, (Hq, Hkv)
        return {
            "x": _w((lambda *s: torch.randn(*s, dtype=torch.bfloat16) * 0.05)(B, Sq, D)),
            "k_cache": _w((lambda *s: torch.randn(*s, dtype=torch.bfloat16) * 3.2)(B, Hkv, Sk, Dh)),
            "v_cache": _w((lambda *s: torch.randn(*s, dtype=torch.bfloat16) * 1.6)(B, Hkv, Sk, Dh)),
            "wq": _w((lambda *s: torch.randn(*s, dtype=torch.bfloat16) * 3.2)(D, Hq * Dh) * (D ** -0.5)),
            "wo": _w((lambda *s: torch.randn(*s, dtype=torch.bfloat16) * 1.6)(Hq * Dh, D) * ((Hq * Dh) ** -0.5)),
        }
    _A_in = _A_setup()

    def _B_setup():
        B, S, D, F = 2, 1, 576, 4608
        return {
            "x": _w((lambda *s: torch.randn(*s, dtype=torch.bfloat16) * 0.05)(B, S, D)),
            "w_gate": _w((lambda *s: torch.randn(*s, dtype=torch.bfloat16) * 0.05)(D, F)),
            "w_up": _w((lambda *s: torch.randn(*s, dtype=torch.bfloat16) * 0.05)(D, F)),
            "w_down": _w((lambda *s: torch.randn(*s, dtype=torch.bfloat16) * 0.05)(F, D)),
        }
    _B_in = _B_setup()

    return {
        "A_x": _A_in["x"],
        "A_k_cache": _A_in["k_cache"],
        "A_v_cache": _A_in["v_cache"],
        "A_wq": _A_in["wq"],
        "A_wo": _A_in["wo"],
        "B_x": _B_in["x"],
        "B_w_gate": _B_in["w_gate"],
        "B_w_up": _B_in["w_up"],
        "B_w_down": _B_in["w_down"],
    }

def reference(A_x, A_k_cache, A_v_cache, A_wq, A_wo, B_x, B_w_gate, B_w_up, B_w_down):
    def _A_ref(x, k_cache, v_cache, wq, wo):
        B, Sq, D = x.shape
        Hq, Dh = 32, 128
        Hkv = k_cache.shape[1]
        rep = Hq // Hkv
        q = (lambda x, *d: x.permute(*d))((x @ wq).reshape(B, Sq, Hq, Dh), 0, 2, 1, 3)
        k = (lambda x, n, axis: torch.repeat_interleave(x, n, dim=axis))(k_cache, rep, axis=1)
        v = (lambda x, n, axis: torch.repeat_interleave(x, n, dim=axis))(v_cache, rep, axis=1)
        scores = torch.einsum("bhqd,bhkd->bhqk", q, k) * (Dh ** -0.5)
        p = _softmax(scores, axis=-1)
        o = torch.einsum("bhqk,bhkd->bhqd", p, v)
        return (lambda x, *d: x.permute(*d))(o, 0, 2, 1, 3).reshape(B, Sq, Hq * Dh) @ wo

    def _B_ref(x, w_gate, w_up, w_down):
        g = _silu(x @ w_gate)
        u = x @ w_up
        return (g * u) @ w_down

    x = A_x
    xn = _layernorm(x, axis=-1)
    return x + _A_ref(xn, A_k_cache, A_v_cache, A_wq, A_wo) + _B_ref(xn, B_w_gate, B_w_up, B_w_down)
```

```asm
; @launch grid=(256,1,1) block=(384,1,1) lds=82944
.amdgcn_target "amdgcn-amd-amdhsa--gfx950"
.text
.globl parallel_sum__gqa_block_cached__swiglu_ffn__decode_kernel
.p2align 8
.type parallel_sum__gqa_block_cached__swiglu_ffn__decode_kernel,@function
parallel_sum__gqa_block_cached__swiglu_ffn__decode_kernel:
    s_cmp_ge_u32 s2, 256
    s_cbranch_scc1 L_exit
    s_load_dwordx16 s[4:19], s[0:1], 0
    s_load_dwordx8 s[20:27], s[0:1], 64
    v_lshrrev_b32 v1, 6, v0
    v_and_b32 v0, 63, v0
    s_nop 0
    v_readfirstlane_b32 s3, v1
    s_cmp_eq_u32 s3, 0
    s_cbranch_scc1 L_s0
    s_cmp_eq_u32 s3, 1
    s_cbranch_scc1 L_s1
L_stream:
    s_sub_u32 s3, s3, 2
    v_lshrrev_b32 v20, 4, v0
    v_and_b32 v21, 15, v0
    s_and_b32 s78, s2, 7
    s_lshl_b32 s86, s78, 5
    s_lshr_b32 s87, s2, 3
    s_add_u32 s86, s86, s87
    s_mul_i32 s79, s86, 0x5556
    s_lshr_b32 s79, s79, 16
    s_mul_i32 s76, s79, 3
    s_sub_u32 s76, s86, s76
    s_cmp_ge_u32 s79, 36
    s_cselect_b32 s77, 36, 0
    s_mov_b32 s50, 0x510000
    s_mov_b32 s51, 0x20000
    s_sub_u32 s75, s79, s77
    s_mul_i32 s74, s76, 1769472
    s_lshl_b32 s77, s75, 8
    s_add_u32 s74, s74, s77
    s_mul_i32 s77, s3, 110592
    s_add_u32 s74, s74, s77
    v_mul_u32_u24 v22, 442368, v20
    v_lshl_add_u32 v22, v21, 4, v22
    s_mul_i32 s77, s3, 12288
    s_add_u32 m0, s77, 33792
    s_cmp_ge_u32 s86, 216
    s_waitcnt lgkmcnt(0)
    s_cbranch_scc1 L_wnogu
    s_cmp_ge_u32 s79, 36
    s_cselect_b32 s48, s18, s16
    s_cselect_b32 s49, s19, s17
    s_waitcnt vmcnt(7)
    buffer_load_dwordx4 v22, s[48:51], s74 offen offset:0 nt lds
    s_add_u32 s74, s74, 9216
    s_add_u32 m0, m0, 1024
    s_waitcnt vmcnt(7)
    buffer_load_dwordx4 v22, s[48:51], s74 offen offset:0 nt lds
    s_add_u32 s74, s74, 9216
    s_add_u32 m0, m0, 1024
    s_waitcnt vmcnt(7)
    buffer_load_dwordx4 v22, s[48:51], s74 offen offset:0 nt lds
    s_add_u32 s74, s74, 9216
    s_add_u32 m0, m0, 1024
    s_waitcnt vmcnt(7)
    buffer_load_dwordx4 v22, s[48:51], s74 offen offset:0 nt lds
    s_add_u32 s74, s74, 9216
    s_add_u32 m0, m0, 1024
    s_waitcnt vmcnt(7)
    buffer_load_dwordx4 v22, s[48:51], s74 offen offset:0 nt lds
    s_add_u32 s74, s74, 9216
    s_add_u32 m0, m0, 1024
    s_waitcnt vmcnt(7)
    buffer_load_dwordx4 v22, s[48:51], s74 offen offset:0 nt lds
    s_add_u32 s74, s74, 9216
    s_add_u32 m0, m0, 1024
    s_waitcnt vmcnt(7)
    buffer_load_dwordx4 v22, s[48:51], s74 offen offset:0 nt lds
    s_add_u32 s74, s74, 9216
    s_add_u32 m0, m0, 1024
    s_waitcnt vmcnt(7)
    buffer_load_dwordx4 v22, s[48:51], s74 offen offset:0 nt lds
    s_barrier
    s_add_u32 s74, s74, 9216
    s_add_u32 m0, m0, 1024
    s_waitcnt vmcnt(7)
    buffer_load_dwordx4 v22, s[48:51], s74 offen offset:0 nt lds
    s_add_u32 s74, s74, 9216
    s_add_u32 m0, m0, 1024
    s_waitcnt vmcnt(7)
    buffer_load_dwordx4 v22, s[48:51], s74 offen offset:0 nt lds
    s_add_u32 s74, s74, 9216
    s_add_u32 m0, m0, 1024
    s_waitcnt vmcnt(7)
    buffer_load_dwordx4 v22, s[48:51], s74 offen offset:0 nt lds
    s_add_u32 s74, s74, 9216
    s_add_u32 m0, m0, 1024
    s_waitcnt vmcnt(7)
    buffer_load_dwordx4 v22, s[48:51], s74 offen offset:0 nt lds
L_wnogu:
    s_load_dword s84, s[26:27], 0xc0000
    s_lshr_b32 s72, s2, 3
    s_lshl_b32 s72, s72, 23
    s_add_u32 s32, s6, s72
    s_addc_u32 s33, s7, 0
    s_mov_b32 s34, 0x800000
    s_mov_b32 s35, 0x20000
    s_add_u32 s36, s8, s72
    s_addc_u32 s37, s9, 0
    s_mov_b32 s38, 0x800000
    s_mov_b32 s39, 0x20000
    v_and_b32 v1, 3, v0
    v_lshlrev_b32 v1, 4, v1
    v_lshl_add_u32 v1, v20, 6, v1
    v_bfe_u32 v3, v0, 2, 2
    v_lshl_add_u32 v1, v3, 8, v1
    v_lshlrev_b32 v2, 4, v0
    s_mov_b32 s72, 0
    s_bitcmp1_b32 s3, 0
    s_cselect_b32 s73, 0x8000, 0
    s_or_b32 s72, s72, s73
    s_bitcmp1_b32 s3, 1
    s_cselect_b32 s73, 0x200000, 0
    s_or_b32 s72, s72, s73
    s_bitcmp1_b32 s2, 0
    s_cselect_b32 s73, 0x1000, 0
    s_or_b32 s72, s72, s73
    s_bitcmp1_b32 s2, 1
    s_cselect_b32 s73, 0x2000, 0
    s_or_b32 s72, s72, s73
    s_bitcmp1_b32 s2, 2
    s_cselect_b32 s73, 0x100000, 0
    s_or_b32 s72, s72, s73
    s_mov_b32 s73, s72
    s_mov_b32 s79, s72
    s_waitcnt vmcnt(5)
    buffer_load_dwordx4 v[48:51], v1, s[32:35], s72 offen offset:0 nt
    s_waitcnt vmcnt(5)
    buffer_load_dwordx4 v[52:55], v1, s[32:35], s72 offen offset:1024 nt
    s_waitcnt vmcnt(5)
    buffer_load_dwordx4 v[56:59], v1, s[32:35], s72 offen offset:2048 nt
    s_waitcnt vmcnt(5)
    buffer_load_dwordx4 v[60:63], v1, s[32:35], s72 offen offset:3072 nt
    s_or_b32 s72, s72, 0xffb0bfff
    s_add_u32 s72, s72, 1
    s_and_b32 s72, s72, 0x4f4000
    s_or_b32 s72, s72, s73
    s_cmp_lt_u32 s86, 216
    s_cbranch_scc1 L_wgu
    s_barrier
L_wgu:
    v_and_b32 v20, 1, v0
    v_cmp_eq_u32 vcc, 1, v20
    v_mov_b32 v20, 0xffff
    v_mov_b32 v21, 0xffff0000
    v_cndmask_b32 v20, v20, v21, vcc
    v_bfe_u32 v21, v0, 1, 2
    v_cmp_eq_u32 vcc, 0, v21
    s_nop 1
    v_cndmask_b32 v8, 0, v20, vcc
    v_cmp_eq_u32 vcc, 1, v21
    s_nop 1
    v_cndmask_b32 v9, 0, v20, vcc
    v_cmp_eq_u32 vcc, 2, v21
    s_nop 1
    v_cndmask_b32 v10, 0, v20, vcc
    v_cmp_eq_u32 vcc, 3, v21
    s_nop 1
    v_cndmask_b32 v11, 0, v20, vcc
    s_mov_b32 s74, 0x3db504f3
    s_mov_b32 s75, 0x3fb8aa3b
    s_mov_b32 s76, 0xbfb8aa3b
    v_mov_b32 v12, 0
    v_mov_b32 v13, 0
    v_mov_b32 v14, 0
    v_mov_b32 v15, 0
    v_mov_b32 v16, 0xff800000
    v_mov_b32 v18, 0
    v_bfe_u32 v3, v0, 3, 1
    v_lshlrev_b32 v3, 8, v3
    v_lshrrev_b32 v19, 4, v0
    v_lshl_add_u32 v3, v19, 6, v3
    v_and_b32 v19, 3, v0
    v_lshl_add_u32 v3, v19, 4, v3
    s_waitcnt vmcnt(5)
    buffer_load_dwordx4 v[64:67], v1, s[32:35], s72 offen offset:0 nt
    s_waitcnt vmcnt(5)
    buffer_load_dwordx4 v[68:71], v1, s[32:35], s72 offen offset:1024 nt
    s_waitcnt vmcnt(5)
    buffer_load_dwordx4 v[72:75], v1, s[32:35], s72 offen offset:2048 nt
    s_waitcnt vmcnt(5)
    buffer_load_dwordx4 v[76:79], v1, s[32:35], s72 offen offset:3072 nt
    s_or_b32 s72, s72, 0xffb0bfff
    s_add_u32 s72, s72, 1
    s_and_b32 s72, s72, 0x4f4000
    s_or_b32 s72, s72, s73
    s_mov_b32 s68, s26
    s_mov_b32 s69, s27
    s_mov_b32 s70, 0x300000
    s_mov_b32 s71, 0x20000
    s_mov_b32 s40, s32
    s_mov_b32 s41, s33
    s_mov_b32 s42, s34
    s_mov_b32 s43, 0x20000
    v_mov_b32 v47, v1
    s_lshl_b32 s78, s3, 12
    s_add_u32 s78, s78, 16896
    v_and_b32 v46, 0x38, v0
    v_add_u32 v46, s78, v46
    s_waitcnt vmcnt(5)
    buffer_load_dwordx4 v[80:83], v1, s[32:35], s72 offen offset:0 nt
    s_waitcnt vmcnt(5)
    buffer_load_dwordx4 v[84:87], v1, s[32:35], s72 offen offset:1024 nt
    s_waitcnt vmcnt(5)
    buffer_load_dwordx4 v[88:91], v1, s[32:35], s72 offen offset:2048 nt
    s_waitcnt vmcnt(5)
    buffer_load_dwordx4 v[92:95], v1, s[32:35], s72 offen offset:3072 nt
    s_or_b32 s72, s72, 0xffb0bfff
    s_add_u32 s72, s72, 1
    s_and_b32 s72, s72, 0x4f4000
    s_or_b32 s72, s72, s73
    v_lshlrev_b32 v41, 2, v0
    v_cmp_eq_u32 vcc, 0, v0
    v_mov_b32 v43, 0
    s_nop 0
    v_cndmask_b32 v42, 0, 1, vcc
    ds_add_u32 v41, v42 offset:780
    s_waitcnt vmcnt(5)
    buffer_load_dwordx4 v[96:99], v1, s[32:35], s72 offen offset:0 nt
    s_waitcnt vmcnt(5)
    buffer_load_dwordx4 v[100:103], v1, s[32:35], s72 offen offset:1024 nt
    s_waitcnt vmcnt(5)
    buffer_load_dwordx4 v[104:107], v1, s[32:35], s72 offen offset:2048 nt
    s_waitcnt vmcnt(5)
    buffer_load_dwordx4 v[108:111], v1, s[32:35], s72 offen offset:3072 nt
    s_or_b32 s72, s72, 0xffb0bfff
    s_add_u32 s72, s72, 1
    s_and_b32 s72, s72, 0x4f4000
    s_or_b32 s72, s72, s73
    s_waitcnt vmcnt(5)
    buffer_load_dwordx4 v[112:115], v1, s[32:35], s72 offen offset:0 nt
    s_waitcnt vmcnt(5)
    buffer_load_dwordx4 v[116:119], v1, s[32:35], s72 offen offset:1024 nt
    s_waitcnt vmcnt(5)
    buffer_load_dwordx4 v[120:123], v1, s[32:35], s72 offen offset:2048 nt
    s_waitcnt vmcnt(5)
    buffer_load_dwordx4 v[124:127], v1, s[32:35], s72 offen offset:3072 nt
    s_or_b32 s72, s72, 0xffb0bfff
    s_add_u32 s72, s72, 1
    s_and_b32 s72, s72, 0x4f4000
    s_or_b32 s72, s72, s73
    ds_add_u32 v41, v42 offset:788
    s_waitcnt vmcnt(5)
    buffer_load_dwordx4 v[128:131], v1, s[32:35], s72 offen offset:0 nt
    s_waitcnt vmcnt(5)
    buffer_load_dwordx4 v[132:135], v1, s[32:35], s72 offen offset:1024 nt
    s_waitcnt vmcnt(5)
    buffer_load_dwordx4 v[136:139], v1, s[32:35], s72 offen offset:2048 nt
    s_waitcnt vmcnt(5)
    buffer_load_dwordx4 v[140:143], v1, s[32:35], s72 offen offset:3072 nt
    s_or_b32 s72, s72, 0xffb0bfff
    s_add_u32 s72, s72, 1
    s_and_b32 s72, s72, 0x4f4000
    s_or_b32 s72, s72, s73
    s_waitcnt vmcnt(5)
    buffer_load_dwordx4 v[144:147], v1, s[32:35], s72 offen offset:0 nt
    s_waitcnt vmcnt(5)
    buffer_load_dwordx4 v[148:151], v1, s[32:35], s72 offen offset:1024 nt
    s_waitcnt vmcnt(5)
    buffer_load_dwordx4 v[152:155], v1, s[32:35], s72 offen offset:2048 nt
    s_waitcnt vmcnt(5)
    buffer_load_dwordx4 v[156:159], v1, s[32:35], s72 offen offset:3072 nt
    s_or_b32 s72, s72, 0xffb0bfff
    s_add_u32 s72, s72, 1
    s_and_b32 s72, s72, 0x4f4000
    s_or_b32 s72, s72, s73
    s_waitcnt vmcnt(5)
    buffer_load_dwordx4 v[160:163], v1, s[32:35], s72 offen offset:0 nt
    s_waitcnt vmcnt(5)
    buffer_load_dwordx4 v[164:167], v1, s[32:35], s72 offen offset:1024 nt
    s_waitcnt vmcnt(5)
    buffer_load_dwordx4 v[168:171], v1, s[32:35], s72 offen offset:2048 nt
    s_waitcnt vmcnt(5)
    buffer_load_dwordx4 v[172:175], v1, s[32:35], s72 offen offset:3072 nt
    s_or_b32 s72, s72, 0xffb0bfff
    s_add_u32 s72, s72, 1
    s_and_b32 s72, s72, 0x4f4000
    s_or_b32 s72, s72, s73
    s_waitcnt vmcnt(5)
    buffer_load_dwordx4 v[176:179], v1, s[32:35], s72 offen offset:0 nt
    s_waitcnt vmcnt(5)
    buffer_load_dwordx4 v[180:183], v1, s[32:35], s72 offen offset:1024 nt
    s_waitcnt vmcnt(5)
    buffer_load_dwordx4 v[184:187], v1, s[32:35], s72 offen offset:2048 nt
    s_waitcnt vmcnt(5)
    buffer_load_dwordx4 v[188:191], v1, s[32:35], s72 offen offset:3072 nt
    s_or_b32 s72, s72, 0xffb0bfff
    s_add_u32 s72, s72, 1
    s_and_b32 s72, s72, 0x4f4000
    s_or_b32 s72, s72, s73
    s_waitcnt vmcnt(5)
    buffer_load_dwordx4 v[192:195], v1, s[32:35], s72 offen offset:0 nt
    s_waitcnt vmcnt(5)
    buffer_load_dwordx4 v[196:199], v1, s[32:35], s72 offen offset:1024 nt
    s_waitcnt vmcnt(5)
    buffer_load_dwordx4 v[200:203], v1, s[32:35], s72 offen offset:2048 nt
    s_waitcnt vmcnt(5)
    buffer_load_dwordx4 v[204:207], v1, s[32:35], s72 offen offset:3072 nt
    s_or_b32 s72, s72, 0xffb0bfff
    s_add_u32 s72, s72, 1
    s_and_b32 s72, s72, 0x4f4000
    s_or_b32 s72, s72, s73
    s_waitcnt vmcnt(5)
    buffer_load_dwordx4 v[208:211], v1, s[32:35], s72 offen offset:0 nt
    s_waitcnt vmcnt(5)
    buffer_load_dwordx4 v[212:215], v1, s[32:35], s72 offen offset:1024 nt
    s_waitcnt vmcnt(5)
    buffer_load_dwordx4 v[216:219], v1, s[32:35], s72 offen offset:2048 nt
    s_waitcnt vmcnt(5)
    buffer_load_dwordx4 v[220:223], v1, s[32:35], s72 offen offset:3072 nt
    s_or_b32 s72, s72, 0xffb0bfff
    s_add_u32 s72, s72, 1
    s_and_b32 s72, s72, 0x4f4000
    s_or_b32 s72, s72, s73
    s_waitcnt vmcnt(5)
    buffer_load_dwordx4 v[224:227], v1, s[32:35], s72 offen offset:0 nt
    s_waitcnt vmcnt(5)
    buffer_load_dwordx4 v[228:231], v1, s[32:35], s72 offen offset:1024 nt
    s_waitcnt vmcnt(5)
    buffer_load_dwordx4 v[232:235], v1, s[32:35], s72 offen offset:2048 nt
    s_waitcnt vmcnt(5)
    buffer_load_dwordx4 v[236:239], v1, s[32:35], s72 offen offset:3072 nt
    s_or_b32 s72, s72, 0xffb0bfff
    s_add_u32 s72, s72, 1
    s_and_b32 s72, s72, 0x4f4000
    s_or_b32 s72, s72, s73
    s_mov_b32 s77, 4194304
L_qw:
    ds_read_b32 v44, v43 offset:784
    s_sub_u32 s77, s77, 1
    s_cbranch_scc1 L_qw2
    s_waitcnt lgkmcnt(0)
    v_readfirstlane_b32 s78, v44
    s_cmp_eq_u32 s78, 0
    s_cbranch_scc1 L_qw
L_qw2:
    ds_read_b128 v[4:7], v3 offset:0
    s_waitcnt lgkmcnt(0)
    s_waitcnt vmcnt(44)
    v_mfma_f32_16x16x32_bf16 v[20:23], v[48:51], v[4:7], 0
    v_mfma_f32_16x16x32_bf16 v[24:27], v[52:55], v[4:7], 0
    v_mfma_f32_16x16x32_bf16 v[28:31], v[56:59], v[4:7], 0
    v_mfma_f32_16x16x32_bf16 v[32:35], v[60:63], v[4:7], 0
    s_waitcnt vmcnt(4)
    buffer_load_dwordx4 v[48:51], v1, s[32:35], s72 offen offset:0 nt
    s_nop 2
    v_mov_b32_dpp v36, v20 quad_perm:[0,0,0,0] row_mask:0xf bank_mask:0xf
    v_mov_b32_dpp v37, v24 quad_perm:[0,0,0,0] row_mask:0xf bank_mask:0xf
    v_mov_b32_dpp v38, v28 quad_perm:[0,0,0,0] row_mask:0xf bank_mask:0xf
    v_mov_b32_dpp v39, v32 quad_perm:[0,0,0,0] row_mask:0xf bank_mask:0xf
    v_add_f32_dpp v36, v21, v36 quad_perm:[1,1,1,1] row_mask:0xf bank_mask:0xf
    v_add_f32_dpp v37, v25, v37 quad_perm:[1,1,1,1] row_mask:0xf bank_mask:0xf
    v_add_f32_dpp v38, v29, v38 quad_perm:[1,1,1,1] row_mask:0xf bank_mask:0xf
    v_add_f32_dpp v39, v33, v39 quad_perm:[1,1,1,1] row_mask:0xf bank_mask:0xf
    v_add_f32_dpp v36, v22, v36 quad_perm:[2,2,2,2] row_mask:0xf bank_mask:0xf
    v_add_f32_dpp v37, v26, v37 quad_perm:[2,2,2,2] row_mask:0xf bank_mask:0xf
    v_add_f32_dpp v38, v30, v38 quad_perm:[2,2,2,2] row_mask:0xf bank_mask:0xf
    v_add_f32_dpp v39, v34, v39 quad_perm:[2,2,2,2] row_mask:0xf bank_mask:0xf
    v_add_f32_dpp v36, v23, v36 quad_perm:[3,3,3,3] row_mask:0xf bank_mask:0xf
    v_add_f32_dpp v37, v27, v37 quad_perm:[3,3,3,3] row_mask:0xf bank_mask:0xf
    v_add_f32_dpp v38, v31, v38 quad_perm:[3,3,3,3] row_mask:0xf bank_mask:0xf
    v_add_f32_dpp v39, v35, v39 quad_perm:[3,3,3,3] row_mask:0xf bank_mask:0xf
    s_waitcnt vmcnt(4)
    buffer_load_dwordx4 v[52:55], v1, s[32:35], s72 offen offset:1024 nt
    v_cvt_pk_bf16_f32 v36, 0, v36
    v_cvt_pk_bf16_f32 v37, 0, v37
    v_cvt_pk_bf16_f32 v38, 0, v38
    v_cvt_pk_bf16_f32 v39, 0, v39
    v_mul_f32 v36, s74, v36
    v_mul_f32 v37, s74, v37
    v_mul_f32 v38, s74, v38
    v_mul_f32 v39, s74, v39
    v_cvt_pk_bf16_f32 v40, v36, v37
    v_cvt_pk_bf16_f32 v41, v38, v39
    v_max3_f32 v16, v16, v36, v37
    v_max3_f32 v16, v16, v38, v39
    ds_write_b64 v46, v[40:41] offset:0
    s_waitcnt vmcnt(30)
    v_mfma_f32_16x16x32_bf16 v[20:23], v[112:115], v[4:7], 0
    v_mfma_f32_16x16x32_bf16 v[24:27], v[116:119], v[4:7], 0
    v_mfma_f32_16x16x32_bf16 v[28:31], v[120:123], v[4:7], 0
    v_mfma_f32_16x16x32_bf16 v[32:35], v[124:127], v[4:7], 0
    s_nop 4
    v_mov_b32_dpp v36, v20 quad_perm:[0,0,0,0] row_mask:0xf bank_mask:0xf
    v_mov_b32_dpp v37, v24 quad_perm:[0,0,0,0] row_mask:0xf bank_mask:0xf
    v_mov_b32_dpp v38, v28 quad_perm:[0,0,0,0] row_mask:0xf bank_mask:0xf
    v_mov_b32_dpp v39, v32 quad_perm:[0,0,0,0] row_mask:0xf bank_mask:0xf
    v_add_f32_dpp v36, v21, v36 quad_perm:[1,1,1,1] row_mask:0xf bank_mask:0xf
    v_add_f32_dpp v37, v25, v37 quad_perm:[1,1,1,1] row_mask:0xf bank_mask:0xf
    v_add_f32_dpp v38, v29, v38 quad_perm:[1,1,1,1] row_mask:0xf bank_mask:0xf
    v_add_f32_dpp v39, v33, v39 quad_perm:[1,1,1,1] row_mask:0xf bank_mask:0xf
    v_add_f32_dpp v36, v22, v36 quad_perm:[2,2,2,2] row_mask:0xf bank_mask:0xf
    v_add_f32_dpp v37, v26, v37 quad_perm:[2,2,2,2] row_mask:0xf bank_mask:0xf
    v_add_f32_dpp v38, v30, v38 quad_perm:[2,2,2,2] row_mask:0xf bank_mask:0xf
    v_add_f32_dpp v39, v34, v39 quad_perm:[2,2,2,2] row_mask:0xf bank_mask:0xf
    v_add_f32_dpp v36, v23, v36 quad_perm:[3,3,3,3] row_mask:0xf bank_mask:0xf
    v_add_f32_dpp v37, v27, v37 quad_perm:[3,3,3,3] row_mask:0xf bank_mask:0xf
    v_add_f32_dpp v38, v31, v38 quad_perm:[3,3,3,3] row_mask:0xf bank_mask:0xf
    v_add_f32_dpp v39, v35, v39 quad_perm:[3,3,3,3] row_mask:0xf bank_mask:0xf
    s_waitcnt vmcnt(4)
    buffer_load_dwordx4 v[56:59], v1, s[32:35], s72 offen offset:2048 nt
    v_cvt_pk_bf16_f32 v36, 0, v36
    v_cvt_pk_bf16_f32 v37, 0, v37
    v_cvt_pk_bf16_f32 v38, 0, v38
    v_cvt_pk_bf16_f32 v39, 0, v39
    v_mul_f32 v36, s74, v36
    v_mul_f32 v37, s74, v37
    v_mul_f32 v38, s74, v38
    v_mul_f32 v39, s74, v39
    v_cvt_pk_bf16_f32 v40, v36, v37
    v_cvt_pk_bf16_f32 v41, v38, v39
    v_max3_f32 v16, v16, v36, v37
    v_max3_f32 v16, v16, v38, v39
    ds_write_b64 v46, v[40:41] offset:256
    s_waitcnt vmcnt(27)
    v_mfma_f32_16x16x32_bf16 v[20:23], v[128:131], v[4:7], 0
    v_mfma_f32_16x16x32_bf16 v[24:27], v[132:135], v[4:7], 0
    v_mfma_f32_16x16x32_bf16 v[28:31], v[136:139], v[4:7], 0
    v_mfma_f32_16x16x32_bf16 v[32:35], v[140:143], v[4:7], 0
    s_nop 4
    v_mov_b32_dpp v36, v20 quad_perm:[0,0,0,0] row_mask:0xf bank_mask:0xf
    v_mov_b32_dpp v37, v24 quad_perm:[0,0,0,0] row_mask:0xf bank_mask:0xf
    v_mov_b32_dpp v38, v28 quad_perm:[0,0,0,0] row_mask:0xf bank_mask:0xf
    v_mov_b32_dpp v39, v32 quad_perm:[0,0,0,0] row_mask:0xf bank_mask:0xf
    v_add_f32_dpp v36, v21, v36 quad_perm:[1,1,1,1] row_mask:0xf bank_mask:0xf
    v_add_f32_dpp v37, v25, v37 quad_perm:[1,1,1,1] row_mask:0xf bank_mask:0xf
    v_add_f32_dpp v38, v29, v38 quad_perm:[1,1,1,1] row_mask:0xf bank_mask:0xf
    v_add_f32_dpp v39, v33, v39 quad_perm:[1,1,1,1] row_mask:0xf bank_mask:0xf
    v_add_f32_dpp v36, v22, v36 quad_perm:[2,2,2,2] row_mask:0xf bank_mask:0xf
    v_add_f32_dpp v37, v26, v37 quad_perm:[2,2,2,2] row_mask:0xf bank_mask:0xf
    v_add_f32_dpp v38, v30, v38 quad_perm:[2,2,2,2] row_mask:0xf bank_mask:0xf
    v_add_f32_dpp v39, v34, v39 quad_perm:[2,2,2,2] row_mask:0xf bank_mask:0xf
    v_add_f32_dpp v36, v23, v36 quad_perm:[3,3,3,3] row_mask:0xf bank_mask:0xf
    v_add_f32_dpp v37, v27, v37 quad_perm:[3,3,3,3] row_mask:0xf bank_mask:0xf
    v_add_f32_dpp v38, v31, v38 quad_perm:[3,3,3,3] row_mask:0xf bank_mask:0xf
    v_add_f32_dpp v39, v35, v39 quad_perm:[3,3,3,3] row_mask:0xf bank_mask:0xf
    s_waitcnt vmcnt(4)
    buffer_load_dwordx4 v[60:63], v1, s[32:35], s72 offen offset:3072 nt
    v_cvt_pk_bf16_f32 v36, 0, v36
    v_cvt_pk_bf16_f32 v37, 0, v37
    v_cvt_pk_bf16_f32 v38, 0, v38
    v_cvt_pk_bf16_f32 v39, 0, v39
    v_mul_f32 v36, s74, v36
    v_mul_f32 v37, s74, v37
    v_mul_f32 v38, s74, v38
    v_mul_f32 v39, s74, v39
    v_cvt_pk_bf16_f32 v40, v36, v37
    v_cvt_pk_bf16_f32 v41, v38, v39
    v_max3_f32 v16, v16, v36, v37
    v_max3_f32 v16, v16, v38, v39
    ds_write_b64 v46, v[40:41] offset:320
    s_or_b32 s72, s72, 0xffb0bfff
    s_add_u32 s72, s72, 1
    s_and_b32 s72, s72, 0x4f4000
    s_or_b32 s72, s72, s73
    s_waitcnt vmcnt(44)
    v_mfma_f32_16x16x32_bf16 v[20:23], v[64:67], v[4:7], 0
    v_mfma_f32_16x16x32_bf16 v[24:27], v[68:71], v[4:7], 0
    v_mfma_f32_16x16x32_bf16 v[28:31], v[72:75], v[4:7], 0
    v_mfma_f32_16x16x32_bf16 v[32:35], v[76:79], v[4:7], 0
    s_waitcnt vmcnt(4)
    buffer_load_dwordx4 v[64:67], v1, s[32:35], s72 offen offset:0 nt
    s_nop 2
    v_mov_b32_dpp v36, v20 quad_perm:[0,0,0,0] row_mask:0xf bank_mask:0xf
    v_mov_b32_dpp v37, v24 quad_perm:[0,0,0,0] row_mask:0xf bank_mask:0xf
    v_mov_b32_dpp v38, v28 quad_perm:[0,0,0,0] row_mask:0xf bank_mask:0xf
    v_mov_b32_dpp v39, v32 quad_perm:[0,0,0,0] row_mask:0xf bank_mask:0xf
    v_add_f32_dpp v36, v21, v36 quad_perm:[1,1,1,1] row_mask:0xf bank_mask:0xf
    v_add_f32_dpp v37, v25, v37 quad_perm:[1,1,1,1] row_mask:0xf bank_mask:0xf
    v_add_f32_dpp v38, v29, v38 quad_perm:[1,1,1,1] row_mask:0xf bank_mask:0xf
    v_add_f32_dpp v39, v33, v39 quad_perm:[1,1,1,1] row_mask:0xf bank_mask:0xf
    v_add_f32_dpp v36, v22, v36 quad_perm:[2,2,2,2] row_mask:0xf bank_mask:0xf
    v_add_f32_dpp v37, v26, v37 quad_perm:[2,2,2,2] row_mask:0xf bank_mask:0xf
    v_add_f32_dpp v38, v30, v38 quad_perm:[2,2,2,2] row_mask:0xf bank_mask:0xf
    v_add_f32_dpp v39, v34, v39 quad_perm:[2,2,2,2] row_mask:0xf bank_mask:0xf
    v_add_f32_dpp v36, v23, v36 quad_perm:[3,3,3,3] row_mask:0xf bank_mask:0xf
    v_add_f32_dpp v37, v27, v37 quad_perm:[3,3,3,3] row_mask:0xf bank_mask:0xf
    v_add_f32_dpp v38, v31, v38 quad_perm:[3,3,3,3] row_mask:0xf bank_mask:0xf
    v_add_f32_dpp v39, v35, v39 quad_perm:[3,3,3,3] row_mask:0xf bank_mask:0xf
    s_waitcnt vmcnt(4)
    buffer_load_dwordx4 v[68:71], v1, s[32:35], s72 offen offset:1024 nt
    v_cvt_pk_bf16_f32 v36, 0, v36
    v_cvt_pk_bf16_f32 v37, 0, v37
    v_cvt_pk_bf16_f32 v38, 0, v38
    v_cvt_pk_bf16_f32 v39, 0, v39
    v_mul_f32 v36, s74, v36
    v_mul_f32 v37, s74, v37
    v_mul_f32 v38, s74, v38
    v_mul_f32 v39, s74, v39
    v_cvt_pk_bf16_f32 v40, v36, v37
    v_cvt_pk_bf16_f32 v41, v38, v39
    v_max3_f32 v16, v16, v36, v37
    v_max3_f32 v16, v16, v38, v39
    ds_write_b64 v46, v[40:41] offset:64
    s_waitcnt vmcnt(26)
    v_mfma_f32_16x16x32_bf16 v[20:23], v[144:147], v[4:7], 0
    v_mfma_f32_16x16x32_bf16 v[24:27], v[148:151], v[4:7], 0
    v_mfma_f32_16x16x32_bf16 v[28:31], v[152:155], v[4:7], 0
    v_mfma_f32_16x16x32_bf16 v[32:35], v[156:159], v[4:7], 0
    s_nop 4
    v_mov_b32_dpp v36, v20 quad_perm:[0,0,0,0] row_mask:0xf bank_mask:0xf
    v_mov_b32_dpp v37, v24 quad_perm:[0,0,0,0] row_mask:0xf bank_mask:0xf
    v_mov_b32_dpp v38, v28 quad_perm:[0,0,0,0] row_mask:0xf bank_mask:0xf
    v_mov_b32_dpp v39, v32 quad_perm:[0,0,0,0] row_mask:0xf bank_mask:0xf
    v_add_f32_dpp v36, v21, v36 quad_perm:[1,1,1,1] row_mask:0xf bank_mask:0xf
    v_add_f32_dpp v37, v25, v37 quad_perm:[1,1,1,1] row_mask:0xf bank_mask:0xf
    v_add_f32_dpp v38, v29, v38 quad_perm:[1,1,1,1] row_mask:0xf bank_mask:0xf
    v_add_f32_dpp v39, v33, v39 quad_perm:[1,1,1,1] row_mask:0xf bank_mask:0xf
    v_add_f32_dpp v36, v22, v36 quad_perm:[2,2,2,2] row_mask:0xf bank_mask:0xf
    v_add_f32_dpp v37, v26, v37 quad_perm:[2,2,2,2] row_mask:0xf bank_mask:0xf
    v_add_f32_dpp v38, v30, v38 quad_perm:[2,2,2,2] row_mask:0xf bank_mask:0xf
    v_add_f32_dpp v39, v34, v39 quad_perm:[2,2,2,2] row_mask:0xf bank_mask:0xf
    v_add_f32_dpp v36, v23, v36 quad_perm:[3,3,3,3] row_mask:0xf bank_mask:0xf
    v_add_f32_dpp v37, v27, v37 quad_perm:[3,3,3,3] row_mask:0xf bank_mask:0xf
    v_add_f32_dpp v38, v31, v38 quad_perm:[3,3,3,3] row_mask:0xf bank_mask:0xf
    v_add_f32_dpp v39, v35, v39 quad_perm:[3,3,3,3] row_mask:0xf bank_mask:0xf
    s_waitcnt vmcnt(4)
    buffer_load_dwordx4 v[72:75], v1, s[32:35], s72 offen offset:2048 nt
    v_cvt_pk_bf16_f32 v36, 0, v36
    v_cvt_pk_bf16_f32 v37, 0, v37
    v_cvt_pk_bf16_f32 v38, 0, v38
    v_cvt_pk_bf16_f32 v39, 0, v39
    v_mul_f32 v36, s74, v36
    v_mul_f32 v37, s74, v37
    v_mul_f32 v38, s74, v38
    v_mul_f32 v39, s74, v39
    v_cvt_pk_bf16_f32 v40, v36, v37
    v_cvt_pk_bf16_f32 v41, v38, v39
    v_max3_f32 v16, v16, v36, v37
    v_max3_f32 v16, v16, v38, v39
    ds_write_b64 v46, v[40:41] offset:384
    s_waitcnt vmcnt(23)
    v_mfma_f32_16x16x32_bf16 v[20:23], v[160:163], v[4:7], 0
    v_mfma_f32_16x16x32_bf16 v[24:27], v[164:167], v[4:7], 0
    v_mfma_f32_16x16x32_bf16 v[28:31], v[168:171], v[4:7], 0
    v_mfma_f32_16x16x32_bf16 v[32:35], v[172:175], v[4:7], 0
    s_nop 4
    v_mov_b32_dpp v36, v20 quad_perm:[0,0,0,0] row_mask:0xf bank_mask:0xf
    v_mov_b32_dpp v37, v24 quad_perm:[0,0,0,0] row_mask:0xf bank_mask:0xf
    v_mov_b32_dpp v38, v28 quad_perm:[0,0,0,0] row_mask:0xf bank_mask:0xf
    v_mov_b32_dpp v39, v32 quad_perm:[0,0,0,0] row_mask:0xf bank_mask:0xf
    v_add_f32_dpp v36, v21, v36 quad_perm:[1,1,1,1] row_mask:0xf bank_mask:0xf
    v_add_f32_dpp v37, v25, v37 quad_perm:[1,1,1,1] row_mask:0xf bank_mask:0xf
    v_add_f32_dpp v38, v29, v38 quad_perm:[1,1,1,1] row_mask:0xf bank_mask:0xf
    v_add_f32_dpp v39, v33, v39 quad_perm:[1,1,1,1] row_mask:0xf bank_mask:0xf
    v_add_f32_dpp v36, v22, v36 quad_perm:[2,2,2,2] row_mask:0xf bank_mask:0xf
    v_add_f32_dpp v37, v26, v37 quad_perm:[2,2,2,2] row_mask:0xf bank_mask:0xf
    v_add_f32_dpp v38, v30, v38 quad_perm:[2,2,2,2] row_mask:0xf bank_mask:0xf
    v_add_f32_dpp v39, v34, v39 quad_perm:[2,2,2,2] row_mask:0xf bank_mask:0xf
    v_add_f32_dpp v36, v23, v36 quad_perm:[3,3,3,3] row_mask:0xf bank_mask:0xf
    v_add_f32_dpp v37, v27, v37 quad_perm:[3,3,3,3] row_mask:0xf bank_mask:0xf
    v_add_f32_dpp v38, v31, v38 quad_perm:[3,3,3,3] row_mask:0xf bank_mask:0xf
    v_add_f32_dpp v39, v35, v39 quad_perm:[3,3,3,3] row_mask:0xf bank_mask:0xf
    s_waitcnt vmcnt(4)
    buffer_load_dwordx4 v[76:79], v1, s[32:35], s72 offen offset:3072 nt
    v_cvt_pk_bf16_f32 v36, 0, v36
    v_cvt_pk_bf16_f32 v37, 0, v37
    v_cvt_pk_bf16_f32 v38, 0, v38
    v_cvt_pk_bf16_f32 v39, 0, v39
    v_mul_f32 v36, s74, v36
    v_mul_f32 v37, s74, v37
    v_mul_f32 v38, s74, v38
    v_mul_f32 v39, s74, v39
    v_cvt_pk_bf16_f32 v40, v36, v37
    v_cvt_pk_bf16_f32 v41, v38, v39
    v_max3_f32 v16, v16, v36, v37
    v_max3_f32 v16, v16, v38, v39
    ds_write_b64 v46, v[40:41] offset:448
    s_or_b32 s72, s72, 0xffb0bfff
    s_add_u32 s72, s72, 1
    s_and_b32 s72, s72, 0x4f4000
    s_or_b32 s72, s72, s73
    s_waitcnt vmcnt(44)
    v_mfma_f32_16x16x32_bf16 v[20:23], v[80:83], v[4:7], 0
    v_mfma_f32_16x16x32_bf16 v[24:27], v[84:87], v[4:7], 0
    v_mfma_f32_16x16x32_bf16 v[28:31], v[88:91], v[4:7], 0
    v_mfma_f32_16x16x32_bf16 v[32:35], v[92:95], v[4:7], 0
    s_waitcnt vmcnt(4)
    buffer_load_dwordx4 v[80:83], v1, s[32:35], s72 offen offset:0 nt
    s_nop 2
    v_mov_b32_dpp v36, v20 quad_perm:[0,0,0,0] row_mask:0xf bank_mask:0xf
    v_mov_b32_dpp v37, v24 quad_perm:[0,0,0,0] row_mask:0xf bank_mask:0xf
    v_mov_b32_dpp v38, v28 quad_perm:[0,0,0,0] row_mask:0xf bank_mask:0xf
    v_mov_b32_dpp v39, v32 quad_perm:[0,0,0,0] row_mask:0xf bank_mask:0xf
    v_add_f32_dpp v36, v21, v36 quad_perm:[1,1,1,1] row_mask:0xf bank_mask:0xf
    v_add_f32_dpp v37, v25, v37 quad_perm:[1,1,1,1] row_mask:0xf bank_mask:0xf
    v_add_f32_dpp v38, v29, v38 quad_perm:[1,1,1,1] row_mask:0xf bank_mask:0xf
    v_add_f32_dpp v39, v33, v39 quad_perm:[1,1,1,1] row_mask:0xf bank_mask:0xf
    v_add_f32_dpp v36, v22, v36 quad_perm:[2,2,2,2] row_mask:0xf bank_mask:0xf
    v_add_f32_dpp v37, v26, v37 quad_perm:[2,2,2,2] row_mask:0xf bank_mask:0xf
    v_add_f32_dpp v38, v30, v38 quad_perm:[2,2,2,2] row_mask:0xf bank_mask:0xf
    v_add_f32_dpp v39, v34, v39 quad_perm:[2,2,2,2] row_mask:0xf bank_mask:0xf
    v_add_f32_dpp v36, v23, v36 quad_perm:[3,3,3,3] row_mask:0xf bank_mask:0xf
    v_add_f32_dpp v37, v27, v37 quad_perm:[3,3,3,3] row_mask:0xf bank_mask:0xf
    v_add_f32_dpp v38, v31, v38 quad_perm:[3,3,3,3] row_mask:0xf bank_mask:0xf
    v_add_f32_dpp v39, v35, v39 quad_perm:[3,3,3,3] row_mask:0xf bank_mask:0xf
    s_waitcnt vmcnt(4)
    buffer_load_dwordx4 v[84:87], v1, s[32:35], s72 offen offset:1024 nt
    v_cvt_pk_bf16_f32 v36, 0, v36
    v_cvt_pk_bf16_f32 v37, 0, v37
    v_cvt_pk_bf16_f32 v38, 0, v38
    v_cvt_pk_bf16_f32 v39, 0, v39
    v_mul_f32 v36, s74, v36
    v_mul_f32 v37, s74, v37
    v_mul_f32 v38, s74, v38
    v_mul_f32 v39, s74, v39
    v_cvt_pk_bf16_f32 v40, v36, v37
    v_cvt_pk_bf16_f32 v41, v38, v39
    v_max3_f32 v16, v16, v36, v37
    v_max3_f32 v16, v16, v38, v39
    ds_write_b64 v46, v[40:41] offset:128
    s_waitcnt vmcnt(22)
    v_mfma_f32_16x16x32_bf16 v[20:23], v[176:179], v[4:7], 0
    v_mfma_f32_16x16x32_bf16 v[24:27], v[180:183], v[4:7], 0
    v_mfma_f32_16x16x32_bf16 v[28:31], v[184:187], v[4:7], 0
    v_mfma_f32_16x16x32_bf16 v[32:35], v[188:191], v[4:7], 0
    s_nop 4
    v_mov_b32_dpp v36, v20 quad_perm:[0,0,0,0] row_mask:0xf bank_mask:0xf
    v_mov_b32_dpp v37, v24 quad_perm:[0,0,0,0] row_mask:0xf bank_mask:0xf
    v_mov_b32_dpp v38, v28 quad_perm:[0,0,0,0] row_mask:0xf bank_mask:0xf
    v_mov_b32_dpp v39, v32 quad_perm:[0,0,0,0] row_mask:0xf bank_mask:0xf
    v_add_f32_dpp v36, v21, v36 quad_perm:[1,1,1,1] row_mask:0xf bank_mask:0xf
    v_add_f32_dpp v37, v25, v37 quad_perm:[1,1,1,1] row_mask:0xf bank_mask:0xf
    v_add_f32_dpp v38, v29, v38 quad_perm:[1,1,1,1] row_mask:0xf bank_mask:0xf
    v_add_f32_dpp v39, v33, v39 quad_perm:[1,1,1,1] row_mask:0xf bank_mask:0xf
    v_add_f32_dpp v36, v22, v36 quad_perm:[2,2,2,2] row_mask:0xf bank_mask:0xf
    v_add_f32_dpp v37, v26, v37 quad_perm:[2,2,2,2] row_mask:0xf bank_mask:0xf
    v_add_f32_dpp v38, v30, v38 quad_perm:[2,2,2,2] row_mask:0xf bank_mask:0xf
    v_add_f32_dpp v39, v34, v39 quad_perm:[2,2,2,2] row_mask:0xf bank_mask:0xf
    v_add_f32_dpp v36, v23, v36 quad_perm:[3,3,3,3] row_mask:0xf bank_mask:0xf
    v_add_f32_dpp v37, v27, v37 quad_perm:[3,3,3,3] row_mask:0xf bank_mask:0xf
    v_add_f32_dpp v38, v31, v38 quad_perm:[3,3,3,3] row_mask:0xf bank_mask:0xf
    v_add_f32_dpp v39, v35, v39 quad_perm:[3,3,3,3] row_mask:0xf bank_mask:0xf
    s_waitcnt vmcnt(4)
    buffer_load_dwordx4 v[88:91], v1, s[32:35], s72 offen offset:2048 nt
    v_cvt_pk_bf16_f32 v36, 0, v36
    v_cvt_pk_bf16_f32 v37, 0, v37
    v_cvt_pk_bf16_f32 v38, 0, v38
    v_cvt_pk_bf16_f32 v39, 0, v39
    v_mul_f32 v36, s74, v36
    v_mul_f32 v37, s74, v37
    v_mul_f32 v38, s74, v38
    v_mul_f32 v39, s74, v39
    v_cvt_pk_bf16_f32 v40, v36, v37
    v_cvt_pk_bf16_f32 v41, v38, v39
    v_max3_f32 v16, v16, v36, v37
    v_max3_f32 v16, v16, v38, v39
    ds_write_b64 v46, v[40:41] offset:512
    s_waitcnt vmcnt(19)
    v_mfma_f32_16x16x32_bf16 v[20:23], v[192:195], v[4:7], 0
    v_mfma_f32_16x16x32_bf16 v[24:27], v[196:199], v[4:7], 0
    v_mfma_f32_16x16x32_bf16 v[28:31], v[200:203], v[4:7], 0
    v_mfma_f32_16x16x32_bf16 v[32:35], v[204:207], v[4:7], 0
    s_nop 4
    v_mov_b32_dpp v36, v20 quad_perm:[0,0,0,0] row_mask:0xf bank_mask:0xf
    v_mov_b32_dpp v37, v24 quad_perm:[0,0,0,0] row_mask:0xf bank_mask:0xf
    v_mov_b32_dpp v38, v28 quad_perm:[0,0,0,0] row_mask:0xf bank_mask:0xf
    v_mov_b32_dpp v39, v32 quad_perm:[0,0,0,0] row_mask:0xf bank_mask:0xf
    v_add_f32_dpp v36, v21, v36 quad_perm:[1,1,1,1] row_mask:0xf bank_mask:0xf
    v_add_f32_dpp v37, v25, v37 quad_perm:[1,1,1,1] row_mask:0xf bank_mask:0xf
    v_add_f32_dpp v38, v29, v38 quad_perm:[1,1,1,1] row_mask:0xf bank_mask:0xf
    v_add_f32_dpp v39, v33, v39 quad_perm:[1,1,1,1] row_mask:0xf bank_mask:0xf
    v_add_f32_dpp v36, v22, v36 quad_perm:[2,2,2,2] row_mask:0xf bank_mask:0xf
    v_add_f32_dpp v37, v26, v37 quad_perm:[2,2,2,2] row_mask:0xf bank_mask:0xf
    v_add_f32_dpp v38, v30, v38 quad_perm:[2,2,2,2] row_mask:0xf bank_mask:0xf
    v_add_f32_dpp v39, v34, v39 quad_perm:[2,2,2,2] row_mask:0xf bank_mask:0xf
    v_add_f32_dpp v36, v23, v36 quad_perm:[3,3,3,3] row_mask:0xf bank_mask:0xf
    v_add_f32_dpp v37, v27, v37 quad_perm:[3,3,3,3] row_mask:0xf bank_mask:0xf
    v_add_f32_dpp v38, v31, v38 quad_perm:[3,3,3,3] row_mask:0xf bank_mask:0xf
    v_add_f32_dpp v39, v35, v39 quad_perm:[3,3,3,3] row_mask:0xf bank_mask:0xf
    s_waitcnt vmcnt(4)
    buffer_load_dwordx4 v[92:95], v1, s[32:35], s72 offen offset:3072 nt
    v_cvt_pk_bf16_f32 v36, 0, v36
    v_cvt_pk_bf16_f32 v37, 0, v37
    v_cvt_pk_bf16_f32 v38, 0, v38
    v_cvt_pk_bf16_f32 v39, 0, v39
    v_mul_f32 v36, s74, v36
    v_mul_f32 v37, s74, v37
    v_mul_f32 v38, s74, v38
    v_mul_f32 v39, s74, v39
    v_cvt_pk_bf16_f32 v40, v36, v37
    v_cvt_pk_bf16_f32 v41, v38, v39
    v_max3_f32 v16, v16, v36, v37
    v_max3_f32 v16, v16, v38, v39
    ds_write_b64 v46, v[40:41] offset:576
    s_or_b32 s72, s72, 0xffb0bfff
    s_add_u32 s72, s72, 1
    s_and_b32 s72, s72, 0x4f4000
    s_or_b32 s72, s72, s73
    s_waitcnt vmcnt(44)
    v_mfma_f32_16x16x32_bf16 v[20:23], v[96:99], v[4:7], 0
    v_mfma_f32_16x16x32_bf16 v[24:27], v[100:103], v[4:7], 0
    v_mfma_f32_16x16x32_bf16 v[28:31], v[104:107], v[4:7], 0
    v_mfma_f32_16x16x32_bf16 v[32:35], v[108:111], v[4:7], 0
    s_waitcnt vmcnt(4)
    buffer_load_dwordx4 v[96:99], v1, s[32:35], s72 offen offset:0 nt
    s_nop 2
    v_mov_b32_dpp v36, v20 quad_perm:[0,0,0,0] row_mask:0xf bank_mask:0xf
    v_mov_b32_dpp v37, v24 quad_perm:[0,0,0,0] row_mask:0xf bank_mask:0xf
    v_mov_b32_dpp v38, v28 quad_perm:[0,0,0,0] row_mask:0xf bank_mask:0xf
    v_mov_b32_dpp v39, v32 quad_perm:[0,0,0,0] row_mask:0xf bank_mask:0xf
    v_add_f32_dpp v36, v21, v36 quad_perm:[1,1,1,1] row_mask:0xf bank_mask:0xf
    v_add_f32_dpp v37, v25, v37 quad_perm:[1,1,1,1] row_mask:0xf bank_mask:0xf
    v_add_f32_dpp v38, v29, v38 quad_perm:[1,1,1,1] row_mask:0xf bank_mask:0xf
    v_add_f32_dpp v39, v33, v39 quad_perm:[1,1,1,1] row_mask:0xf bank_mask:0xf
    v_add_f32_dpp v36, v22, v36 quad_perm:[2,2,2,2] row_mask:0xf bank_mask:0xf
    v_add_f32_dpp v37, v26, v37 quad_perm:[2,2,2,2] row_mask:0xf bank_mask:0xf
    v_add_f32_dpp v38, v30, v38 quad_perm:[2,2,2,2] row_mask:0xf bank_mask:0xf
    v_add_f32_dpp v39, v34, v39 quad_perm:[2,2,2,2] row_mask:0xf bank_mask:0xf
    v_add_f32_dpp v36, v23, v36 quad_perm:[3,3,3,3] row_mask:0xf bank_mask:0xf
    v_add_f32_dpp v37, v27, v37 quad_perm:[3,3,3,3] row_mask:0xf bank_mask:0xf
    v_add_f32_dpp v38, v31, v38 quad_perm:[3,3,3,3] row_mask:0xf bank_mask:0xf
    v_add_f32_dpp v39, v35, v39 quad_perm:[3,3,3,3] row_mask:0xf bank_mask:0xf
    s_waitcnt vmcnt(4)
    buffer_load_dwordx4 v[100:103], v1, s[32:35], s72 offen offset:1024 nt
    v_cvt_pk_bf16_f32 v36, 0, v36
    v_cvt_pk_bf16_f32 v37, 0, v37
    v_cvt_pk_bf16_f32 v38, 0, v38
    v_cvt_pk_bf16_f32 v39, 0, v39
    v_mul_f32 v36, s74, v36
    v_mul_f32 v37, s74, v37
    v_mul_f32 v38, s74, v38
    v_mul_f32 v39, s74, v39
    v_cvt_pk_bf16_f32 v40, v36, v37
    v_cvt_pk_bf16_f32 v41, v38, v39
    v_max3_f32 v16, v16, v36, v37
    v_max3_f32 v16, v16, v38, v39
    ds_write_b64 v46, v[40:41] offset:192
    s_waitcnt vmcnt(18)
    v_mfma_f32_16x16x32_bf16 v[20:23], v[208:211], v[4:7], 0
    v_mfma_f32_16x16x32_bf16 v[24:27], v[212:215], v[4:7], 0
    v_mfma_f32_16x16x32_bf16 v[28:31], v[216:219], v[4:7], 0
    v_mfma_f32_16x16x32_bf16 v[32:35], v[220:223], v[4:7], 0
    s_nop 4
    v_mov_b32_dpp v36, v20 quad_perm:[0,0,0,0] row_mask:0xf bank_mask:0xf
    v_mov_b32_dpp v37, v24 quad_perm:[0,0,0,0] row_mask:0xf bank_mask:0xf
    v_mov_b32_dpp v38, v28 quad_perm:[0,0,0,0] row_mask:0xf bank_mask:0xf
    v_mov_b32_dpp v39, v32 quad_perm:[0,0,0,0] row_mask:0xf bank_mask:0xf
    v_add_f32_dpp v36, v21, v36 quad_perm:[1,1,1,1] row_mask:0xf bank_mask:0xf
    v_add_f32_dpp v37, v25, v37 quad_perm:[1,1,1,1] row_mask:0xf bank_mask:0xf
    v_add_f32_dpp v38, v29, v38 quad_perm:[1,1,1,1] row_mask:0xf bank_mask:0xf
    v_add_f32_dpp v39, v33, v39 quad_perm:[1,1,1,1] row_mask:0xf bank_mask:0xf
    v_add_f32_dpp v36, v22, v36 quad_perm:[2,2,2,2] row_mask:0xf bank_mask:0xf
    v_add_f32_dpp v37, v26, v37 quad_perm:[2,2,2,2] row_mask:0xf bank_mask:0xf
    v_add_f32_dpp v38, v30, v38 quad_perm:[2,2,2,2] row_mask:0xf bank_mask:0xf
    v_add_f32_dpp v39, v34, v39 quad_perm:[2,2,2,2] row_mask:0xf bank_mask:0xf
    v_add_f32_dpp v36, v23, v36 quad_perm:[3,3,3,3] row_mask:0xf bank_mask:0xf
    v_add_f32_dpp v37, v27, v37 quad_perm:[3,3,3,3] row_mask:0xf bank_mask:0xf
    v_add_f32_dpp v38, v31, v38 quad_perm:[3,3,3,3] row_mask:0xf bank_mask:0xf
    v_add_f32_dpp v39, v35, v39 quad_perm:[3,3,3,3] row_mask:0xf bank_mask:0xf
    s_waitcnt vmcnt(4)
    buffer_load_dwordx4 v[104:107], v1, s[32:35], s72 offen offset:2048 nt
    v_cvt_pk_bf16_f32 v36, 0, v36
    v_cvt_pk_bf16_f32 v37, 0, v37
    v_cvt_pk_bf16_f32 v38, 0, v38
    v_cvt_pk_bf16_f32 v39, 0, v39
    v_mul_f32 v36, s74, v36
    v_mul_f32 v37, s74, v37
    v_mul_f32 v38, s74, v38
    v_mul_f32 v39, s74, v39
    v_cvt_pk_bf16_f32 v40, v36, v37
    v_cvt_pk_bf16_f32 v41, v38, v39
    v_max3_f32 v16, v16, v36, v37
    v_max3_f32 v16, v16, v38, v39
    ds_write_b64 v46, v[40:41] offset:640
    s_waitcnt vmcnt(15)
    v_mfma_f32_16x16x32_bf16 v[20:23], v[224:227], v[4:7], 0
    v_mfma_f32_16x16x32_bf16 v[24:27], v[228:231], v[4:7], 0
    v_mfma_f32_16x16x32_bf16 v[28:31], v[232:235], v[4:7], 0
    v_mfma_f32_16x16x32_bf16 v[32:35], v[236:239], v[4:7], 0
    s_nop 4
    v_mov_b32_dpp v36, v20 quad_perm:[0,0,0,0] row_mask:0xf bank_mask:0xf
    v_mov_b32_dpp v37, v24 quad_perm:[0,0,0,0] row_mask:0xf bank_mask:0xf
    v_mov_b32_dpp v38, v28 quad_perm:[0,0,0,0] row_mask:0xf bank_mask:0xf
    v_mov_b32_dpp v39, v32 quad_perm:[0,0,0,0] row_mask:0xf bank_mask:0xf
    v_add_f32_dpp v36, v21, v36 quad_perm:[1,1,1,1] row_mask:0xf bank_mask:0xf
    v_add_f32_dpp v37, v25, v37 quad_perm:[1,1,1,1] row_mask:0xf bank_mask:0xf
    v_add_f32_dpp v38, v29, v38 quad_perm:[1,1,1,1] row_mask:0xf bank_mask:0xf
    v_add_f32_dpp v39, v33, v39 quad_perm:[1,1,1,1] row_mask:0xf bank_mask:0xf
    v_add_f32_dpp v36, v22, v36 quad_perm:[2,2,2,2] row_mask:0xf bank_mask:0xf
    v_add_f32_dpp v37, v26, v37 quad_perm:[2,2,2,2] row_mask:0xf bank_mask:0xf
    v_add_f32_dpp v38, v30, v38 quad_perm:[2,2,2,2] row_mask:0xf bank_mask:0xf
    v_add_f32_dpp v39, v34, v39 quad_perm:[2,2,2,2] row_mask:0xf bank_mask:0xf
    v_add_f32_dpp v36, v23, v36 quad_perm:[3,3,3,3] row_mask:0xf bank_mask:0xf
    v_add_f32_dpp v37, v27, v37 quad_perm:[3,3,3,3] row_mask:0xf bank_mask:0xf
    v_add_f32_dpp v38, v31, v38 quad_perm:[3,3,3,3] row_mask:0xf bank_mask:0xf
    v_add_f32_dpp v39, v35, v39 quad_perm:[3,3,3,3] row_mask:0xf bank_mask:0xf
    s_waitcnt vmcnt(4)
    buffer_load_dwordx4 v[108:111], v1, s[32:35], s72 offen offset:3072 nt
    v_cvt_pk_bf16_f32 v36, 0, v36
    v_cvt_pk_bf16_f32 v37, 0, v37
    v_cvt_pk_bf16_f32 v38, 0, v38
    v_cvt_pk_bf16_f32 v39, 0, v39
    v_mul_f32 v36, s74, v36
    v_mul_f32 v37, s74, v37
    v_mul_f32 v38, s74, v38
    v_mul_f32 v39, s74, v39
    v_cvt_pk_bf16_f32 v40, v36, v37
    v_cvt_pk_bf16_f32 v41, v38, v39
    v_max3_f32 v16, v16, v36, v37
    v_max3_f32 v16, v16, v38, v39
    ds_write_b64 v46, v[40:41] offset:704
    s_or_b32 s72, s72, 0xffb0bfff
    s_add_u32 s72, s72, 1
    s_and_b32 s72, s72, 0x4f4000
    s_or_b32 s72, s72, s73
    s_mov_b32 s77, 11
L_kloop:
    s_cmp_lg_u32 s77, 1
    s_cbranch_scc1 L_knosw
    s_mov_b32 s40, s36
    s_mov_b32 s41, s37
    s_mov_b32 s72, s79
    v_mov_b32 v47, v2
L_knosw:
    s_waitcnt vmcnt(12)
    v_mfma_f32_16x16x32_bf16 v[20:23], v[48:51], v[4:7], 0
    v_mfma_f32_16x16x32_bf16 v[24:27], v[52:55], v[4:7], 0
    v_mfma_f32_16x16x32_bf16 v[28:31], v[56:59], v[4:7], 0
    v_mfma_f32_16x16x32_bf16 v[32:35], v[60:63], v[4:7], 0
    s_waitcnt vmcnt(4)
    buffer_load_dwordx4 v[48:51], v47, s[40:43], s72 offen offset:0 nt
    s_nop 2
    v_mov_b32_dpp v36, v20 quad_perm:[0,0,0,0] row_mask:0xf bank_mask:0xf
    v_mov_b32_dpp v37, v24 quad_perm:[0,0,0,0] row_mask:0xf bank_mask:0xf
    v_mov_b32_dpp v38, v28 quad_perm:[0,0,0,0] row_mask:0xf bank_mask:0xf
    v_mov_b32_dpp v39, v32 quad_perm:[0,0,0,0] row_mask:0xf bank_mask:0xf
    v_add_f32_dpp v36, v21, v36 quad_perm:[1,1,1,1] row_mask:0xf bank_mask:0xf
    v_add_f32_dpp v37, v25, v37 quad_perm:[1,1,1,1] row_mask:0xf bank_mask:0xf
    v_add_f32_dpp v38, v29, v38 quad_perm:[1,1,1,1] row_mask:0xf bank_mask:0xf
    v_add_f32_dpp v39, v33, v39 quad_perm:[1,1,1,1] row_mask:0xf bank_mask:0xf
    s_waitcnt vmcnt(4)
    buffer_load_dwordx4 v[52:55], v47, s[40:43], s72 offen offset:1024 nt
    v_add_f32_dpp v36, v22, v36 quad_perm:[2,2,2,2] row_mask:0xf bank_mask:0xf
    v_add_f32_dpp v37, v26, v37 quad_perm:[2,2,2,2] row_mask:0xf bank_mask:0xf
    v_add_f32_dpp v38, v30, v38 quad_perm:[2,2,2,2] row_mask:0xf bank_mask:0xf
    v_add_f32_dpp v39, v34, v39 quad_perm:[2,2,2,2] row_mask:0xf bank_mask:0xf
    v_add_f32_dpp v36, v23, v36 quad_perm:[3,3,3,3] row_mask:0xf bank_mask:0xf
    v_add_f32_dpp v37, v27, v37 quad_perm:[3,3,3,3] row_mask:0xf bank_mask:0xf
    v_add_f32_dpp v38, v31, v38 quad_perm:[3,3,3,3] row_mask:0xf bank_mask:0xf
    v_add_f32_dpp v39, v35, v39 quad_perm:[3,3,3,3] row_mask:0xf bank_mask:0xf
    s_waitcnt vmcnt(4)
    buffer_load_dwordx4 v[56:59], v47, s[40:43], s72 offen offset:2048 nt
    v_cvt_pk_bf16_f32 v36, 0, v36
    v_cvt_pk_bf16_f32 v37, 0, v37
    v_cvt_pk_bf16_f32 v38, 0, v38
    v_cvt_pk_bf16_f32 v39, 0, v39
    v_mul_f32 v36, s74, v36
    v_mul_f32 v37, s74, v37
    v_mul_f32 v38, s74, v38
    v_mul_f32 v39, s74, v39
    v_cvt_pk_bf16_f32 v40, v36, v37
    v_cvt_pk_bf16_f32 v41, v38, v39
    v_max3_f32 v16, v16, v36, v37
    v_max3_f32 v16, v16, v38, v39
    ds_write_b64 v46, v[40:41] offset:768
    s_waitcnt vmcnt(4)
    buffer_load_dwordx4 v[60:63], v47, s[40:43], s72 offen offset:3072 nt
    s_or_b32 s72, s72, 0xffb0bfff
    s_add_u32 s72, s72, 1
    s_and_b32 s72, s72, 0x4f4000
    s_or_b32 s72, s72, s73
    s_waitcnt vmcnt(12)
    v_mfma_f32_16x16x32_bf16 v[20:23], v[64:67], v[4:7], 0
    v_mfma_f32_16x16x32_bf16 v[24:27], v[68:71], v[4:7], 0
    v_mfma_f32_16x16x32_bf16 v[28:31], v[72:75], v[4:7], 0
    v_mfma_f32_16x16x32_bf16 v[32:35], v[76:79], v[4:7], 0
    s_waitcnt vmcnt(4)
    buffer_load_dwordx4 v[64:67], v47, s[40:43], s72 offen offset:0 nt
    s_nop 2
    v_mov_b32_dpp v36, v20 quad_perm:[0,0,0,0] row_mask:0xf bank_mask:0xf
    v_mov_b32_dpp v37, v24 quad_perm:[0,0,0,0] row_mask:0xf bank_mask:0xf
    v_mov_b32_dpp v38, v28 quad_perm:[0,0,0,0] row_mask:0xf bank_mask:0xf
    v_mov_b32_dpp v39, v32 quad_perm:[0,0,0,0] row_mask:0xf bank_mask:0xf
    v_add_f32_dpp v36, v21, v36 quad_perm:[1,1,1,1] row_mask:0xf bank_mask:0xf
    v_add_f32_dpp v37, v25, v37 quad_perm:[1,1,1,1] row_mask:0xf bank_mask:0xf
    v_add_f32_dpp v38, v29, v38 quad_perm:[1,1,1,1] row_mask:0xf bank_mask:0xf
    v_add_f32_dpp v39, v33, v39 quad_perm:[1,1,1,1] row_mask:0xf bank_mask:0xf
    s_waitcnt vmcnt(4)
    buffer_load_dwordx4 v[68:71], v47, s[40:43], s72 offen offset:1024 nt
    v_add_f32_dpp v36, v22, v36 quad_perm:[2,2,2,2] row_mask:0xf bank_mask:0xf
    v_add_f32_dpp v37, v26, v37 quad_perm:[2,2,2,2] row_mask:0xf bank_mask:0xf
    v_add_f32_dpp v38, v30, v38 quad_perm:[2,2,2,2] row_mask:0xf bank_mask:0xf
    v_add_f32_dpp v39, v34, v39 quad_perm:[2,2,2,2] row_mask:0xf bank_mask:0xf
    v_add_f32_dpp v36, v23, v36 quad_perm:[3,3,3,3] row_mask:0xf bank_mask:0xf
    v_add_f32_dpp v37, v27, v37 quad_perm:[3,3,3,3] row_mask:0xf bank_mask:0xf
    v_add_f32_dpp v38, v31, v38 quad_perm:[3,3,3,3] row_mask:0xf bank_mask:0xf
    v_add_f32_dpp v39, v35, v39 quad_perm:[3,3,3,3] row_mask:0xf bank_mask:0xf
    s_waitcnt vmcnt(4)
    buffer_load_dwordx4 v[72:75], v47, s[40:43], s72 offen offset:2048 nt
    v_cvt_pk_bf16_f32 v36, 0, v36
    v_cvt_pk_bf16_f32 v37, 0, v37
    v_cvt_pk_bf16_f32 v38, 0, v38
    v_cvt_pk_bf16_f32 v39, 0, v39
    v_mul_f32 v36, s74, v36
    v_mul_f32 v37, s74, v37
    v_mul_f32 v38, s74, v38
    v_mul_f32 v39, s74, v39
    v_cvt_pk_bf16_f32 v40, v36, v37
    v_cvt_pk_bf16_f32 v41, v38, v39
    v_max3_f32 v16, v16, v36, v37
    v_max3_f32 v16, v16, v38, v39
    ds_write_b64 v46, v[40:41] offset:832
    s_waitcnt vmcnt(4)
    buffer_load_dwordx4 v[76:79], v47, s[40:43], s72 offen offset:3072 nt
    s_or_b32 s72, s72, 0xffb0bfff
    s_add_u32 s72, s72, 1
    s_and_b32 s72, s72, 0x4f4000
    s_or_b32 s72, s72, s73
    s_waitcnt vmcnt(12)
    v_mfma_f32_16x16x32_bf16 v[20:23], v[80:83], v[4:7], 0
    v_mfma_f32_16x16x32_bf16 v[24:27], v[84:87], v[4:7], 0
    v_mfma_f32_16x16x32_bf16 v[28:31], v[88:91], v[4:7], 0
    v_mfma_f32_16x16x32_bf16 v[32:35], v[92:95], v[4:7], 0
    s_waitcnt vmcnt(4)
    buffer_load_dwordx4 v[80:83], v47, s[40:43], s72 offen offset:0 nt
    s_nop 2
    v_mov_b32_dpp v36, v20 quad_perm:[0,0,0,0] row_mask:0xf bank_mask:0xf
    v_mov_b32_dpp v37, v24 quad_perm:[0,0,0,0] row_mask:0xf bank_mask:0xf
    v_mov_b32_dpp v38, v28 quad_perm:[0,0,0,0] row_mask:0xf bank_mask:0xf
    v_mov_b32_dpp v39, v32 quad_perm:[0,0,0,0] row_mask:0xf bank_mask:0xf
    v_add_f32_dpp v36, v21, v36 quad_perm:[1,1,1,1] row_mask:0xf bank_mask:0xf
    v_add_f32_dpp v37, v25, v37 quad_perm:[1,1,1,1] row_mask:0xf bank_mask:0xf
    v_add_f32_dpp v38, v29, v38 quad_perm:[1,1,1,1] row_mask:0xf bank_mask:0xf
    v_add_f32_dpp v39, v33, v39 quad_perm:[1,1,1,1] row_mask:0xf bank_mask:0xf
    s_waitcnt vmcnt(4)
    buffer_load_dwordx4 v[84:87], v47, s[40:43], s72 offen offset:1024 nt
    v_add_f32_dpp v36, v22, v36 quad_perm:[2,2,2,2] row_mask:0xf bank_mask:0xf
    v_add_f32_dpp v37, v26, v37 quad_perm:[2,2,2,2] row_mask:0xf bank_mask:0xf
    v_add_f32_dpp v38, v30, v38 quad_perm:[2,2,2,2] row_mask:0xf bank_mask:0xf
    v_add_f32_dpp v39, v34, v39 quad_perm:[2,2,2,2] row_mask:0xf bank_mask:0xf
    v_add_f32_dpp v36, v23, v36 quad_perm:[3,3,3,3] row_mask:0xf bank_mask:0xf
    v_add_f32_dpp v37, v27, v37 quad_perm:[3,3,3,3] row_mask:0xf bank_mask:0xf
    v_add_f32_dpp v38, v31, v38 quad_perm:[3,3,3,3] row_mask:0xf bank_mask:0xf
    v_add_f32_dpp v39, v35, v39 quad_perm:[3,3,3,3] row_mask:0xf bank_mask:0xf
    s_waitcnt vmcnt(4)
    buffer_load_dwordx4 v[88:91], v47, s[40:43], s72 offen offset:2048 nt
    v_cvt_pk_bf16_f32 v36, 0, v36
    v_cvt_pk_bf16_f32 v37, 0, v37
    v_cvt_pk_bf16_f32 v38, 0, v38
    v_cvt_pk_bf16_f32 v39, 0, v39
    v_mul_f32 v36, s74, v36
    v_mul_f32 v37, s74, v37
    v_mul_f32 v38, s74, v38
    v_mul_f32 v39, s74, v39
    v_cvt_pk_bf16_f32 v40, v36, v37
    v_cvt_pk_bf16_f32 v41, v38, v39
    v_max3_f32 v16, v16, v36, v37
    v_max3_f32 v16, v16, v38, v39
    ds_write_b64 v46, v[40:41] offset:896
    s_waitcnt vmcnt(4)
    buffer_load_dwordx4 v[92:95], v47, s[40:43], s72 offen offset:3072 nt
    s_or_b32 s72, s72, 0xffb0bfff
    s_add_u32 s72, s72, 1
    s_and_b32 s72, s72, 0x4f4000
    s_or_b32 s72, s72, s73
    s_waitcnt vmcnt(12)
    v_mfma_f32_16x16x32_bf16 v[20:23], v[96:99], v[4:7], 0
    v_mfma_f32_16x16x32_bf16 v[24:27], v[100:103], v[4:7], 0
    v_mfma_f32_16x16x32_bf16 v[28:31], v[104:107], v[4:7], 0
    v_mfma_f32_16x16x32_bf16 v[32:35], v[108:111], v[4:7], 0
    s_waitcnt vmcnt(4)
    buffer_load_dwordx4 v[96:99], v47, s[40:43], s72 offen offset:0 nt
    s_nop 2
    v_mov_b32_dpp v36, v20 quad_perm:[0,0,0,0] row_mask:0xf bank_mask:0xf
    v_mov_b32_dpp v37, v24 quad_perm:[0,0,0,0] row_mask:0xf bank_mask:0xf
    v_mov_b32_dpp v38, v28 quad_perm:[0,0,0,0] row_mask:0xf bank_mask:0xf
    v_mov_b32_dpp v39, v32 quad_perm:[0,0,0,0] row_mask:0xf bank_mask:0xf
    v_add_f32_dpp v36, v21, v36 quad_perm:[1,1,1,1] row_mask:0xf bank_mask:0xf
    v_add_f32_dpp v37, v25, v37 quad_perm:[1,1,1,1] row_mask:0xf bank_mask:0xf
    v_add_f32_dpp v38, v29, v38 quad_perm:[1,1,1,1] row_mask:0xf bank_mask:0xf
    v_add_f32_dpp v39, v33, v39 quad_perm:[1,1,1,1] row_mask:0xf bank_mask:0xf
    s_waitcnt vmcnt(4)
    buffer_load_dwordx4 v[100:103], v47, s[40:43], s72 offen offset:1024 nt
    v_add_f32_dpp v36, v22, v36 quad_perm:[2,2,2,2] row_mask:0xf bank_mask:0xf
    v_add_f32_dpp v37, v26, v37 quad_perm:[2,2,2,2] row_mask:0xf bank_mask:0xf
    v_add_f32_dpp v38, v30, v38 quad_perm:[2,2,2,2] row_mask:0xf bank_mask:0xf
    v_add_f32_dpp v39, v34, v39 quad_perm:[2,2,2,2] row_mask:0xf bank_mask:0xf
    v_add_f32_dpp v36, v23, v36 quad_perm:[3,3,3,3] row_mask:0xf bank_mask:0xf
    v_add_f32_dpp v37, v27, v37 quad_perm:[3,3,3,3] row_mask:0xf bank_mask:0xf
    v_add_f32_dpp v38, v31, v38 quad_perm:[3,3,3,3] row_mask:0xf bank_mask:0xf
    v_add_f32_dpp v39, v35, v39 quad_perm:[3,3,3,3] row_mask:0xf bank_mask:0xf
    s_waitcnt vmcnt(4)
    buffer_load_dwordx4 v[104:107], v47, s[40:43], s72 offen offset:2048 nt
    v_cvt_pk_bf16_f32 v36, 0, v36
    v_cvt_pk_bf16_f32 v37, 0, v37
    v_cvt_pk_bf16_f32 v38, 0, v38
    v_cvt_pk_bf16_f32 v39, 0, v39
    v_mul_f32 v36, s74, v36
    v_mul_f32 v37, s74, v37
    v_mul_f32 v38, s74, v38
    v_mul_f32 v39, s74, v39
    v_cvt_pk_bf16_f32 v40, v36, v37
    v_cvt_pk_bf16_f32 v41, v38, v39
    v_max3_f32 v16, v16, v36, v37
    v_max3_f32 v16, v16, v38, v39
    ds_write_b64 v46, v[40:41] offset:960
    s_waitcnt vmcnt(4)
    buffer_load_dwordx4 v[108:111], v47, s[40:43], s72 offen offset:3072 nt
    s_or_b32 s72, s72, 0xffb0bfff
    s_add_u32 s72, s72, 1
    s_and_b32 s72, s72, 0x4f4000
    s_or_b32 s72, s72, s73
    v_add_u32 v46, 256, v46
    s_sub_u32 s77, s77, 1
    s_cmp_lg_u32 s77, 0
    s_cbranch_scc1 L_kloop
    v_subrev_u32 v46, 2816, v46
    v_mov_b32 v3, v16
    ds_read_b64 v[112:113], v46
    s_nop 0
    v_permlane16_swap_b32 v16, v3
    s_nop 0
    v_max_f32 v16, v16, v3
    v_mov_b32 v3, v16
    s_nop 1
    v_permlane32_swap_b32 v16, v3
    s_nop 0
    v_max_f32 v16, v16, v3
    v_cvt_pk_bf16_f32 v16, 0, v16
    v_mul_f32 v17, s76, v16
    s_mov_b32 s77, 13
L_vloop:
    s_waitcnt lgkmcnt(0)
    ds_read_b64 v[114:115], v46 offset:64
    v_lshlrev_b32 v36, 16, v112
    v_and_b32 v37, 0xffff0000, v112
    v_lshlrev_b32 v38, 16, v113
    v_and_b32 v39, 0xffff0000, v113
    v_fma_f32 v36, v36, s75, v17
    v_fma_f32 v37, v37, s75, v17
    v_fma_f32 v38, v38, s75, v17
    v_fma_f32 v39, v39, s75, v17
    v_exp_f32 v36, v36
    v_exp_f32 v37, v37
    v_exp_f32 v38, v38
    v_exp_f32 v39, v39
    s_waitcnt vmcnt(12)
    v_add_f32 v3, v36, v37
    v_add_f32 v19, v38, v39
    v_cvt_pk_bf16_f32 v36, v36, v36
    v_cvt_pk_bf16_f32 v37, v37, v37
    v_cvt_pk_bf16_f32 v38, v38, v38
    v_cvt_pk_bf16_f32 v39, v39, v39
    v_add_f32 v3, v3, v19
    v_and_b32 v20, v36, v8
    v_and_b32 v21, v36, v9
    v_and_b32 v22, v36, v10
    v_and_b32 v23, v36, v11
    v_add_f32 v18, v18, v3
    v_and_b32 v24, v37, v8
    v_and_b32 v25, v37, v9
    v_and_b32 v26, v37, v10
    v_and_b32 v27, v37, v11
    v_mfma_f32_16x16x32_bf16 v[12:15], v[48:51], v[20:23], v[12:15]
    s_waitcnt vmcnt(4)
    buffer_load_dwordx4 v[48:51], v2, s[36:39], s72 offen offset:0 nt
    v_and_b32 v28, v38, v8
    v_and_b32 v29, v38, v9
    v_and_b32 v30, v38, v10
    v_and_b32 v31, v38, v11
    v_mfma_f32_16x16x32_bf16 v[12:15], v[52:55], v[24:27], v[12:15]
    s_waitcnt vmcnt(4)
    buffer_load_dwordx4 v[52:55], v2, s[36:39], s72 offen offset:1024 nt
    v_and_b32 v32, v39, v8
    v_and_b32 v33, v39, v9
    v_and_b32 v34, v39, v10
    v_and_b32 v35, v39, v11
    v_mfma_f32_16x16x32_bf16 v[12:15], v[56:59], v[28:31], v[12:15]
    s_waitcnt vmcnt(4)
    buffer_load_dwordx4 v[56:59], v2, s[36:39], s72 offen offset:2048 nt
    v_mfma_f32_16x16x32_bf16 v[12:15], v[60:63], v[32:35], v[12:15]
    s_waitcnt vmcnt(4)
    buffer_load_dwordx4 v[60:63], v2, s[36:39], s72 offen offset:3072 nt
    s_or_b32 s72, s72, 0xffb0bfff
    s_add_u32 s72, s72, 1
    s_and_b32 s72, s72, 0x4f4000
    s_or_b32 s72, s72, s73
    s_waitcnt lgkmcnt(0)
    ds_read_b64 v[112:113], v46 offset:128
    v_lshlrev_b32 v36, 16, v114
    v_and_b32 v37, 0xffff0000, v114
    v_lshlrev_b32 v38, 16, v115
    v_and_b32 v39, 0xffff0000, v115
    v_fma_f32 v36, v36, s75, v17
    v_fma_f32 v37, v37, s75, v17
    v_fma_f32 v38, v38, s75, v17
    v_fma_f32 v39, v39, s75, v17
    v_exp_f32 v36, v36
    v_exp_f32 v37, v37
    v_exp_f32 v38, v38
    v_exp_f32 v39, v39
    s_waitcnt vmcnt(12)
    v_add_f32 v3, v36, v37
    v_add_f32 v19, v38, v39
    v_cvt_pk_bf16_f32 v36, v36, v36
    v_cvt_pk_bf16_f32 v37, v37, v37
    v_cvt_pk_bf16_f32 v38, v38, v38
    v_cvt_pk_bf16_f32 v39, v39, v39
    v_add_f32 v3, v3, v19
    v_and_b32 v20, v36, v8
    v_and_b32 v21, v36, v9
    v_and_b32 v22, v36, v10
    v_and_b32 v23, v36, v11
    v_add_f32 v18, v18, v3
    v_and_b32 v24, v37, v8
    v_and_b32 v25, v37, v9
    v_and_b32 v26, v37, v10
    v_and_b32 v27, v37, v11
    v_mfma_f32_16x16x32_bf16 v[12:15], v[64:67], v[20:23], v[12:15]
    s_waitcnt vmcnt(4)
    buffer_load_dwordx4 v[64:67], v2, s[36:39], s72 offen offset:0 nt
    v_and_b32 v28, v38, v8
    v_and_b32 v29, v38, v9
    v_and_b32 v30, v38, v10
    v_and_b32 v31, v38, v11
    v_mfma_f32_16x16x32_bf16 v[12:15], v[68:71], v[24:27], v[12:15]
    s_waitcnt vmcnt(4)
    buffer_load_dwordx4 v[68:71], v2, s[36:39], s72 offen offset:1024 nt
    v_and_b32 v32, v39, v8
    v_and_b32 v33, v39, v9
    v_and_b32 v34, v39, v10
    v_and_b32 v35, v39, v11
    v_mfma_f32_16x16x32_bf16 v[12:15], v[72:75], v[28:31], v[12:15]
    s_waitcnt vmcnt(4)
    buffer_load_dwordx4 v[72:75], v2, s[36:39], s72 offen offset:2048 nt
    v_mfma_f32_16x16x32_bf16 v[12:15], v[76:79], v[32:35], v[12:15]
    s_waitcnt vmcnt(4)
    buffer_load_dwordx4 v[76:79], v2, s[36:39], s72 offen offset:3072 nt
    s_or_b32 s72, s72, 0xffb0bfff
    s_add_u32 s72, s72, 1
    s_and_b32 s72, s72, 0x4f4000
    s_or_b32 s72, s72, s73
    s_waitcnt lgkmcnt(0)
    ds_read_b64 v[114:115], v46 offset:192
    v_lshlrev_b32 v36, 16, v112
    v_and_b32 v37, 0xffff0000, v112
    v_lshlrev_b32 v38, 16, v113
    v_and_b32 v39, 0xffff0000, v113
    v_fma_f32 v36, v36, s75, v17
    v_fma_f32 v37, v37, s75, v17
    v_fma_f32 v38, v38, s75, v17
    v_fma_f32 v39, v39, s75, v17
    v_exp_f32 v36, v36
    v_exp_f32 v37, v37
    v_exp_f32 v38, v38
    v_exp_f32 v39, v39
    s_waitcnt vmcnt(12)
    v_add_f32 v3, v36, v37
    v_add_f32 v19, v38, v39
    v_cvt_pk_bf16_f32 v36, v36, v36
    v_cvt_pk_bf16_f32 v37, v37, v37
    v_cvt_pk_bf16_f32 v38, v38, v38
    v_cvt_pk_bf16_f32 v39, v39, v39
    v_add_f32 v3, v3, v19
    v_and_b32 v20, v36, v8
    v_and_b32 v21, v36, v9
    v_and_b32 v22, v36, v10
    v_and_b32 v23, v36, v11
    v_add_f32 v18, v18, v3
    v_and_b32 v24, v37, v8
    v_and_b32 v25, v37, v9
    v_and_b32 v26, v37, v10
    v_and_b32 v27, v37, v11
    v_mfma_f32_16x16x32_bf16 v[12:15], v[80:83], v[20:23], v[12:15]
    s_waitcnt vmcnt(4)
    buffer_load_dwordx4 v[80:83], v2, s[36:39], s72 offen offset:0 nt
    v_and_b32 v28, v38, v8
    v_and_b32 v29, v38, v9
    v_and_b32 v30, v38, v10
    v_and_b32 v31, v38, v11
    v_mfma_f32_16x16x32_bf16 v[12:15], v[84:87], v[24:27], v[12:15]
    s_waitcnt vmcnt(4)
    buffer_load_dwordx4 v[84:87], v2, s[36:39], s72 offen offset:1024 nt
    v_and_b32 v32, v39, v8
    v_and_b32 v33, v39, v9
    v_and_b32 v34, v39, v10
    v_and_b32 v35, v39, v11
    v_mfma_f32_16x16x32_bf16 v[12:15], v[88:91], v[28:31], v[12:15]
    s_waitcnt vmcnt(4)
    buffer_load_dwordx4 v[88:91], v2, s[36:39], s72 offen offset:2048 nt
    v_mfma_f32_16x16x32_bf16 v[12:15], v[92:95], v[32:35], v[12:15]
    s_waitcnt vmcnt(4)
    buffer_load_dwordx4 v[92:95], v2, s[36:39], s72 offen offset:3072 nt
    s_or_b32 s72, s72, 0xffb0bfff
    s_add_u32 s72, s72, 1
    s_and_b32 s72, s72, 0x4f4000
    s_or_b32 s72, s72, s73
    s_waitcnt lgkmcnt(0)
    ds_read_b64 v[112:113], v46 offset:256
    v_lshlrev_b32 v36, 16, v114
    v_and_b32 v37, 0xffff0000, v114
    v_lshlrev_b32 v38, 16, v115
    v_and_b32 v39, 0xffff0000, v115
    v_fma_f32 v36, v36, s75, v17
    v_fma_f32 v37, v37, s75, v17
    v_fma_f32 v38, v38, s75, v17
    v_fma_f32 v39, v39, s75, v17
    v_exp_f32 v36, v36
    v_exp_f32 v37, v37
    v_exp_f32 v38, v38
    v_exp_f32 v39, v39
    s_waitcnt vmcnt(12)
    v_add_f32 v3, v36, v37
    v_add_f32 v19, v38, v39
    v_cvt_pk_bf16_f32 v36, v36, v36
    v_cvt_pk_bf16_f32 v37, v37, v37
    v_cvt_pk_bf16_f32 v38, v38, v38
    v_cvt_pk_bf16_f32 v39, v39, v39
    v_add_f32 v3, v3, v19
    v_and_b32 v20, v36, v8
    v_and_b32 v21, v36, v9
    v_and_b32 v22, v36, v10
    v_and_b32 v23, v36, v11
    v_add_f32 v18, v18, v3
    v_and_b32 v24, v37, v8
    v_and_b32 v25, v37, v9
    v_and_b32 v26, v37, v10
    v_and_b32 v27, v37, v11
    v_mfma_f32_16x16x32_bf16 v[12:15], v[96:99], v[20:23], v[12:15]
    s_waitcnt vmcnt(4)
    buffer_load_dwordx4 v[96:99], v2, s[36:39], s72 offen offset:0 nt
    v_and_b32 v28, v38, v8
    v_and_b32 v29, v38, v9
    v_and_b32 v30, v38, v10
    v_and_b32 v31, v38, v11
    v_mfma_f32_16x16x32_bf16 v[12:15], v[100:103], v[24:27], v[12:15]
    s_waitcnt vmcnt(4)
    buffer_load_dwordx4 v[100:103], v2, s[36:39], s72 offen offset:1024 nt
    v_and_b32 v32, v39, v8
    v_and_b32 v33, v39, v9
    v_and_b32 v34, v39, v10
    v_and_b32 v35, v39, v11
    v_mfma_f32_16x16x32_bf16 v[12:15], v[104:107], v[28:31], v[12:15]
    s_waitcnt vmcnt(4)
    buffer_load_dwordx4 v[104:107], v2, s[36:39], s72 offen offset:2048 nt
    v_mfma_f32_16x16x32_bf16 v[12:15], v[108:111], v[32:35], v[12:15]
    s_waitcnt vmcnt(4)
    buffer_load_dwordx4 v[108:111], v2, s[36:39], s72 offen offset:3072 nt
    s_or_b32 s72, s72, 0xffb0bfff
    s_add_u32 s72, s72, 1
    s_and_b32 s72, s72, 0x4f4000
    s_or_b32 s72, s72, s73
    v_add_u32 v46, 256, v46
    s_sub_u32 s77, s77, 1
    s_cmp_lg_u32 s77, 0
    s_cbranch_scc1 L_vloop
    v_lshlrev_b32 v41, 2, v0
    v_cmp_eq_u32 vcc, 0, v0
    v_mov_b32 v43, 0
    v_mov_b32 v44, 1
    v_cndmask_b32 v42, 0, 1, vcc
    ds_write_b32 v43, v44 offset:768
    s_waitcnt lgkmcnt(0)
    ds_read_b64 v[114:115], v46 offset:64
    v_lshlrev_b32 v36, 16, v112
    v_and_b32 v37, 0xffff0000, v112
    v_lshlrev_b32 v38, 16, v113
    v_and_b32 v39, 0xffff0000, v113
    v_fma_f32 v36, v36, s75, v17
    v_fma_f32 v37, v37, s75, v17
    v_fma_f32 v38, v38, s75, v17
    v_fma_f32 v39, v39, s75, v17
    v_exp_f32 v36, v36
    v_exp_f32 v37, v37
    v_exp_f32 v38, v38
    v_exp_f32 v39, v39
    s_waitcnt vmcnt(12)
    v_add_f32 v3, v36, v37
    v_add_f32 v19, v38, v39
    v_cvt_pk_bf16_f32 v36, v36, v36
    v_cvt_pk_bf16_f32 v37, v37, v37
    v_cvt_pk_bf16_f32 v38, v38, v38
    v_cvt_pk_bf16_f32 v39, v39, v39
    v_add_f32 v3, v3, v19
    v_and_b32 v20, v36, v8
    v_and_b32 v21, v36, v9
    v_and_b32 v22, v36, v10
    v_and_b32 v23, v36, v11
    v_add_f32 v18, v18, v3
    v_and_b32 v24, v37, v8
    v_and_b32 v25, v37, v9
    v_and_b32 v26, v37, v10
    v_and_b32 v27, v37, v11
    v_mfma_f32_16x16x32_bf16 v[12:15], v[48:51], v[20:23], v[12:15]
    s_waitcnt vmcnt(4)
    buffer_load_dwordx4 v[48:51], v1, s[32:35], s72 offen offset:0 nt
    v_and_b32 v28, v38, v8
    v_and_b32 v29, v38, v9
    v_and_b32 v30, v38, v10
    v_and_b32 v31, v38, v11
    v_mfma_f32_16x16x32_bf16 v[12:15], v[52:55], v[24:27], v[12:15]
    s_waitcnt vmcnt(4)
    buffer_load_dwordx4 v[52:55], v1, s[32:35], s72 offen offset:1024 nt
    v_and_b32 v32, v39, v8
    v_and_b32 v33, v39, v9
    v_and_b32 v34, v39, v10
    v_and_b32 v35, v39, v11
    v_mfma_f32_16x16x32_bf16 v[12:15], v[56:59], v[28:31], v[12:15]
    s_waitcnt vmcnt(4)
    buffer_load_dwordx4 v[56:59], v1, s[32:35], s72 offen offset:2048 nt
    v_mfma_f32_16x16x32_bf16 v[12:15], v[60:63], v[32:35], v[12:15]
    s_waitcnt vmcnt(4)
    buffer_load_dwordx4 v[60:63], v1, s[32:35], s72 offen offset:3072 nt
    s_waitcnt lgkmcnt(0)
    ds_read_b64 v[112:113], v46 offset:128
    v_lshlrev_b32 v36, 16, v114
    v_and_b32 v37, 0xffff0000, v114
    v_lshlrev_b32 v38, 16, v115
    v_and_b32 v39, 0xffff0000, v115
    v_fma_f32 v36, v36, s75, v17
    v_fma_f32 v37, v37, s75, v17
    v_fma_f32 v38, v38, s75, v17
    v_fma_f32 v39, v39, s75, v17
    v_exp_f32 v36, v36
    v_exp_f32 v37, v37
    v_exp_f32 v38, v38
    v_exp_f32 v39, v39
    s_waitcnt vmcnt(12)
    v_add_f32 v3, v36, v37
    v_add_f32 v19, v38, v39
    v_cvt_pk_bf16_f32 v36, v36, v36
    v_cvt_pk_bf16_f32 v37, v37, v37
    v_cvt_pk_bf16_f32 v38, v38, v38
    v_cvt_pk_bf16_f32 v39, v39, v39
    v_add_f32 v3, v3, v19
    v_and_b32 v20, v36, v8
    v_and_b32 v21, v36, v9
    v_and_b32 v22, v36, v10
    v_and_b32 v23, v36, v11
    v_add_f32 v18, v18, v3
    v_and_b32 v24, v37, v8
    v_and_b32 v25, v37, v9
    v_and_b32 v26, v37, v10
    v_and_b32 v27, v37, v11
    v_mfma_f32_16x16x32_bf16 v[12:15], v[64:67], v[20:23], v[12:15]
    s_waitcnt vmcnt(4)
    buffer_load_dwordx4 v[64:67], v2, s[36:39], s72 offen offset:0 nt
    v_and_b32 v28, v38, v8
    v_and_b32 v29, v38, v9
    v_and_b32 v30, v38, v10
    v_and_b32 v31, v38, v11
    v_mfma_f32_16x16x32_bf16 v[12:15], v[68:71], v[24:27], v[12:15]
    s_waitcnt vmcnt(4)
    buffer_load_dwordx4 v[68:71], v2, s[36:39], s72 offen offset:1024 nt
    v_and_b32 v32, v39, v8
    v_and_b32 v33, v39, v9
    v_and_b32 v34, v39, v10
    v_and_b32 v35, v39, v11
    v_mfma_f32_16x16x32_bf16 v[12:15], v[72:75], v[28:31], v[12:15]
    s_waitcnt vmcnt(4)
    buffer_load_dwordx4 v[72:75], v2, s[36:39], s72 offen offset:2048 nt
    v_mfma_f32_16x16x32_bf16 v[12:15], v[76:79], v[32:35], v[12:15]
    s_waitcnt vmcnt(4)
    buffer_load_dwordx4 v[76:79], v2, s[36:39], s72 offen offset:3072 nt
    s_or_b32 s72, s72, 0xffb0bfff
    s_add_u32 s72, s72, 1
    s_and_b32 s72, s72, 0x4f4000
    s_or_b32 s72, s72, s73
    s_waitcnt lgkmcnt(0)
    ds_add_rtn_u32 v40, v41, v42 offset:512
    ds_read_b64 v[114:115], v46 offset:192
    v_lshlrev_b32 v36, 16, v112
    v_and_b32 v37, 0xffff0000, v112
    v_lshlrev_b32 v38, 16, v113
    v_and_b32 v39, 0xffff0000, v113
    v_fma_f32 v36, v36, s75, v17
    v_fma_f32 v37, v37, s75, v17
    v_fma_f32 v38, v38, s75, v17
    v_fma_f32 v39, v39, s75, v17
    v_exp_f32 v36, v36
    v_exp_f32 v37, v37
    v_exp_f32 v38, v38
    v_exp_f32 v39, v39
    s_waitcnt vmcnt(12)
    v_add_f32 v3, v36, v37
    v_add_f32 v19, v38, v39
    v_cvt_pk_bf16_f32 v36, v36, v36
    v_cvt_pk_bf16_f32 v37, v37, v37
    v_cvt_pk_bf16_f32 v38, v38, v38
    v_cvt_pk_bf16_f32 v39, v39, v39
    v_add_f32 v3, v3, v19
    v_and_b32 v20, v36, v8
    v_and_b32 v21, v36, v9
    v_and_b32 v22, v36, v10
    v_and_b32 v23, v36, v11
    v_add_f32 v18, v18, v3
    v_and_b32 v24, v37, v8
    v_and_b32 v25, v37, v9
    v_and_b32 v26, v37, v10
    v_and_b32 v27, v37, v11
    v_mfma_f32_16x16x32_bf16 v[12:15], v[80:83], v[20:23], v[12:15]
    s_waitcnt vmcnt(4)
    buffer_load_dwordx4 v[80:83], v1, s[32:35], s72 offen offset:0 nt
    v_and_b32 v28, v38, v8
    v_and_b32 v29, v38, v9
    v_and_b32 v30, v38, v10
    v_and_b32 v31, v38, v11
    v_mfma_f32_16x16x32_bf16 v[12:15], v[84:87], v[24:27], v[12:15]
    s_waitcnt vmcnt(4)
    buffer_load_dwordx4 v[84:87], v1, s[32:35], s72 offen offset:1024 nt
    v_and_b32 v32, v39, v8
    v_and_b32 v33, v39, v9
    v_and_b32 v34, v39, v10
    v_and_b32 v35, v39, v11
    v_mfma_f32_16x16x32_bf16 v[12:15], v[88:91], v[28:31], v[12:15]
    s_waitcnt vmcnt(4)
    buffer_load_dwordx4 v[88:91], v1, s[32:35], s72 offen offset:2048 nt
    v_mfma_f32_16x16x32_bf16 v[12:15], v[92:95], v[32:35], v[12:15]
    s_waitcnt vmcnt(4)
    buffer_load_dwordx4 v[92:95], v1, s[32:35], s72 offen offset:3072 nt
    s_waitcnt lgkmcnt(0)
    s_waitcnt lgkmcnt(0)
    v_lshlrev_b32 v44, 2, v40
    ds_read_b32 v43, v44 offset:12800
    v_lshlrev_b32 v36, 16, v114
    v_and_b32 v37, 0xffff0000, v114
    v_lshlrev_b32 v38, 16, v115
    v_and_b32 v39, 0xffff0000, v115
    v_fma_f32 v36, v36, s75, v17
    v_fma_f32 v37, v37, s75, v17
    v_fma_f32 v38, v38, s75, v17
    v_fma_f32 v39, v39, s75, v17
    v_exp_f32 v36, v36
    v_exp_f32 v37, v37
    v_exp_f32 v38, v38
    v_exp_f32 v39, v39
    s_waitcnt vmcnt(12)
    v_add_f32 v3, v36, v37
    v_add_f32 v19, v38, v39
    v_cvt_pk_bf16_f32 v36, v36, v36
    v_cvt_pk_bf16_f32 v37, v37, v37
    v_cvt_pk_bf16_f32 v38, v38, v38
    v_cvt_pk_bf16_f32 v39, v39, v39
    v_add_f32 v3, v3, v19
    v_and_b32 v20, v36, v8
    v_and_b32 v21, v36, v9
    v_and_b32 v22, v36, v10
    v_and_b32 v23, v36, v11
    v_add_f32 v18, v18, v3
    v_and_b32 v24, v37, v8
    v_and_b32 v25, v37, v9
    v_and_b32 v26, v37, v10
    v_and_b32 v27, v37, v11
    v_mfma_f32_16x16x32_bf16 v[12:15], v[96:99], v[20:23], v[12:15]
    s_waitcnt vmcnt(4)
    buffer_load_dwordx4 v[96:99], v2, s[36:39], s72 offen offset:0 nt
    v_and_b32 v28, v38, v8
    v_and_b32 v29, v38, v9
    v_and_b32 v30, v38, v10
    v_and_b32 v31, v38, v11
    v_mfma_f32_16x16x32_bf16 v[12:15], v[100:103], v[24:27], v[12:15]
    s_waitcnt vmcnt(4)
    buffer_load_dwordx4 v[100:103], v2, s[36:39], s72 offen offset:1024 nt
    v_and_b32 v32, v39, v8
    v_and_b32 v33, v39, v9
    v_and_b32 v34, v39, v10
    v_and_b32 v35, v39, v11
    v_mfma_f32_16x16x32_bf16 v[12:15], v[104:107], v[28:31], v[12:15]
    s_waitcnt vmcnt(4)
    buffer_load_dwordx4 v[104:107], v2, s[36:39], s72 offen offset:2048 nt
    v_mfma_f32_16x16x32_bf16 v[12:15], v[108:111], v[32:35], v[12:15]
    s_waitcnt vmcnt(4)
    buffer_load_dwordx4 v[108:111], v2, s[36:39], s72 offen offset:3072 nt
    s_mov_b32 s77, 1048576
L_dloop:
L_rt_2:
    s_waitcnt lgkmcnt(0)
    v_readfirstlane_b32 s78, v43
    s_cmp_lg_u32 s78, -1
    s_cbranch_scc1 L_tk_1
    ds_read_b32 v43, v44 offset:12800
    s_sub_u32 s77, s77, 1
    s_cbranch_scc0 L_rt_2
L_tk_1:
    s_cmp_ge_u32 s78, 0x800000
    s_cbranch_scc1 L_drain0
    s_and_b32 s72, s78, -2
    s_bitcmp1_b32 s78, 0
    s_cbranch_scc1 L_fast0
    s_waitcnt vmcnt(12)
    v_mfma_f32_16x16x32_bf16 v[20:23], v[48:51], v[4:7], 0
    v_mfma_f32_16x16x32_bf16 v[24:27], v[52:55], v[4:7], 0
    v_mfma_f32_16x16x32_bf16 v[28:31], v[56:59], v[4:7], 0
    v_mfma_f32_16x16x32_bf16 v[32:35], v[60:63], v[4:7], 0
    s_waitcnt vmcnt(4)
    buffer_load_dwordx4 v[48:51], v1, s[32:35], s72 offen offset:0 nt
    s_nop 2
    v_mov_b32_dpp v36, v20 quad_perm:[0,0,0,0] row_mask:0xf bank_mask:0xf
    v_mov_b32_dpp v37, v24 quad_perm:[0,0,0,0] row_mask:0xf bank_mask:0xf
    v_mov_b32_dpp v38, v28 quad_perm:[0,0,0,0] row_mask:0xf bank_mask:0xf
    v_mov_b32_dpp v39, v32 quad_perm:[0,0,0,0] row_mask:0xf bank_mask:0xf
    v_add_f32_dpp v36, v21, v36 quad_perm:[1,1,1,1] row_mask:0xf bank_mask:0xf
    v_add_f32_dpp v37, v25, v37 quad_perm:[1,1,1,1] row_mask:0xf bank_mask:0xf
    v_add_f32_dpp v38, v29, v38 quad_perm:[1,1,1,1] row_mask:0xf bank_mask:0xf
    v_add_f32_dpp v39, v33, v39 quad_perm:[1,1,1,1] row_mask:0xf bank_mask:0xf
    s_waitcnt vmcnt(4)
    buffer_load_dwordx4 v[52:55], v1, s[32:35], s72 offen offset:1024 nt
    ds_add_rtn_u32 v40, v41, v42 offset:512
    v_add_f32_dpp v36, v22, v36 quad_perm:[2,2,2,2] row_mask:0xf bank_mask:0xf
    v_add_f32_dpp v37, v26, v37 quad_perm:[2,2,2,2] row_mask:0xf bank_mask:0xf
    v_add_f32_dpp v38, v30, v38 quad_perm:[2,2,2,2] row_mask:0xf bank_mask:0xf
    v_add_f32_dpp v39, v34, v39 quad_perm:[2,2,2,2] row_mask:0xf bank_mask:0xf
    v_add_f32_dpp v36, v23, v36 quad_perm:[3,3,3,3] row_mask:0xf bank_mask:0xf
    v_add_f32_dpp v37, v27, v37 quad_perm:[3,3,3,3] row_mask:0xf bank_mask:0xf
    v_add_f32_dpp v38, v31, v38 quad_perm:[3,3,3,3] row_mask:0xf bank_mask:0xf
    v_add_f32_dpp v39, v35, v39 quad_perm:[3,3,3,3] row_mask:0xf bank_mask:0xf
    v_cvt_pk_bf16_f32 v36, 0, v36
    v_cvt_pk_bf16_f32 v37, 0, v37
    v_cvt_pk_bf16_f32 v38, 0, v38
    v_cvt_pk_bf16_f32 v39, 0, v39
    s_waitcnt vmcnt(4)
    buffer_load_dwordx4 v[56:59], v1, s[32:35], s72 offen offset:2048 nt
    v_mul_f32 v36, s74, v36
    v_mul_f32 v37, s74, v37
    v_mul_f32 v38, s74, v38
    v_mul_f32 v39, s74, v39
    v_cvt_pk_bf16_f32 v36, 0, v36
    v_cvt_pk_bf16_f32 v37, 0, v37
    v_cvt_pk_bf16_f32 v38, 0, v38
    v_cvt_pk_bf16_f32 v39, 0, v39
    v_max3_f32 v19, v36, v37, v38
    v_max_f32 v19, v19, v39
    v_cmp_gt_f32 vcc, v19, v16
    s_waitcnt vmcnt(4)
    buffer_load_dwordx4 v[60:63], v1, s[32:35], s72 offen offset:3072 nt
    s_cbranch_vccz L_skip_3
    v_mov_b32 v3, v19
    s_nop 1
    v_permlane16_swap_b32 v19, v3
    s_nop 0
    v_max_f32 v19, v19, v3
    v_mov_b32 v3, v19
    s_nop 1
    v_permlane32_swap_b32 v19, v3
    s_nop 0
    v_max3_f32 v19, v19, v3, v16
    v_sub_f32 v3, v16, v19
    v_mul_f32 v3, s75, v3
    v_exp_f32 v3, v3
    v_mov_b32 v16, v19
    v_mul_f32 v17, s76, v19
    v_mul_f32 v18, v18, v3
    v_mul_f32 v12, v12, v3
    v_mul_f32 v13, v13, v3
    v_mul_f32 v14, v14, v3
    v_mul_f32 v15, v15, v3
L_skip_3:
    v_fma_f32 v36, v36, s75, v17
    v_fma_f32 v37, v37, s75, v17
    v_fma_f32 v38, v38, s75, v17
    v_fma_f32 v39, v39, s75, v17
    v_exp_f32 v36, v36
    v_exp_f32 v37, v37
    v_exp_f32 v38, v38
    v_exp_f32 v39, v39
    s_waitcnt vmcnt(12)
    s_waitcnt lgkmcnt(0)
    v_lshlrev_b32 v44, 2, v40
    ds_read_b32 v43, v44 offset:12800
    v_add_f32 v3, v36, v37
    v_add_f32 v19, v38, v39
    v_cvt_pk_bf16_f32 v36, v36, v36
    v_cvt_pk_bf16_f32 v37, v37, v37
    v_cvt_pk_bf16_f32 v38, v38, v38
    v_cvt_pk_bf16_f32 v39, v39, v39
    v_add_f32 v3, v3, v19
    v_and_b32 v20, v36, v8
    v_and_b32 v21, v36, v9
    v_and_b32 v22, v36, v10
    v_and_b32 v23, v36, v11
    v_add_f32 v18, v18, v3
    v_and_b32 v24, v37, v8
    v_and_b32 v25, v37, v9
    v_and_b32 v26, v37, v10
    v_and_b32 v27, v37, v11
    v_mfma_f32_16x16x32_bf16 v[12:15], v[64:67], v[20:23], v[12:15]
    s_waitcnt vmcnt(4)
    buffer_load_dwordx4 v[64:67], v2, s[36:39], s72 offen offset:0 nt
    v_and_b32 v28, v38, v8
    v_and_b32 v29, v38, v9
    v_and_b32 v30, v38, v10
    v_and_b32 v31, v38, v11
    v_mfma_f32_16x16x32_bf16 v[12:15], v[68:71], v[24:27], v[12:15]
    s_waitcnt vmcnt(4)
    buffer_load_dwordx4 v[68:71], v2, s[36:39], s72 offen offset:1024 nt
    v_and_b32 v32, v39, v8
    v_and_b32 v33, v39, v9
    v_and_b32 v34, v39, v10
    v_and_b32 v35, v39, v11
    v_mfma_f32_16x16x32_bf16 v[12:15], v[72:75], v[28:31], v[12:15]
    s_waitcnt vmcnt(4)
    buffer_load_dwordx4 v[72:75], v2, s[36:39], s72 offen offset:2048 nt
    v_mfma_f32_16x16x32_bf16 v[12:15], v[76:79], v[32:35], v[12:15]
    s_waitcnt vmcnt(4)
    buffer_load_dwordx4 v[76:79], v2, s[36:39], s72 offen offset:3072 nt
L_rt_5:
    s_waitcnt lgkmcnt(0)
    v_readfirstlane_b32 s78, v43
    s_cmp_lg_u32 s78, -1
    s_cbranch_scc1 L_tk_4
    ds_read_b32 v43, v44 offset:12800
    s_sub_u32 s77, s77, 1
    s_cbranch_scc0 L_rt_5
L_tk_4:
    s_cmp_ge_u32 s78, 0x800000
    s_cbranch_scc1 L_drain1
    s_and_b32 s72, s78, -2
    s_bitcmp1_b32 s78, 0
    s_cbranch_scc1 L_fast1
    s_waitcnt vmcnt(12)
    v_mfma_f32_16x16x32_bf16 v[20:23], v[80:83], v[4:7], 0
    v_mfma_f32_16x16x32_bf16 v[24:27], v[84:87], v[4:7], 0
    v_mfma_f32_16x16x32_bf16 v[28:31], v[88:91], v[4:7], 0
    v_mfma_f32_16x16x32_bf16 v[32:35], v[92:95], v[4:7], 0
    s_waitcnt vmcnt(4)
    buffer_load_dwordx4 v[80:83], v1, s[32:35], s72 offen offset:0 nt
    s_nop 2
    v_mov_b32_dpp v36, v20 quad_perm:[0,0,0,0] row_mask:0xf bank_mask:0xf
    v_mov_b32_dpp v37, v24 quad_perm:[0,0,0,0] row_mask:0xf bank_mask:0xf
    v_mov_b32_dpp v38, v28 quad_perm:[0,0,0,0] row_mask:0xf bank_mask:0xf
    v_mov_b32_dpp v39, v32 quad_perm:[0,0,0,0] row_mask:0xf bank_mask:0xf
    v_add_f32_dpp v36, v21, v36 quad_perm:[1,1,1,1] row_mask:0xf bank_mask:0xf
    v_add_f32_dpp v37, v25, v37 quad_perm:[1,1,1,1] row_mask:0xf bank_mask:0xf
    v_add_f32_dpp v38, v29, v38 quad_perm:[1,1,1,1] row_mask:0xf bank_mask:0xf
    v_add_f32_dpp v39, v33, v39 quad_perm:[1,1,1,1] row_mask:0xf bank_mask:0xf
    s_waitcnt vmcnt(4)
    buffer_load_dwordx4 v[84:87], v1, s[32:35], s72 offen offset:1024 nt
    ds_add_rtn_u32 v40, v41, v42 offset:512
    v_add_f32_dpp v36, v22, v36 quad_perm:[2,2,2,2] row_mask:0xf bank_mask:0xf
    v_add_f32_dpp v37, v26, v37 quad_perm:[2,2,2,2] row_mask:0xf bank_mask:0xf
    v_add_f32_dpp v38, v30, v38 quad_perm:[2,2,2,2] row_mask:0xf bank_mask:0xf
    v_add_f32_dpp v39, v34, v39 quad_perm:[2,2,2,2] row_mask:0xf bank_mask:0xf
    v_add_f32_dpp v36, v23, v36 quad_perm:[3,3,3,3] row_mask:0xf bank_mask:0xf
    v_add_f32_dpp v37, v27, v37 quad_perm:[3,3,3,3] row_mask:0xf bank_mask:0xf
    v_add_f32_dpp v38, v31, v38 quad_perm:[3,3,3,3] row_mask:0xf bank_mask:0xf
    v_add_f32_dpp v39, v35, v39 quad_perm:[3,3,3,3] row_mask:0xf bank_mask:0xf
    v_cvt_pk_bf16_f32 v36, 0, v36
    v_cvt_pk_bf16_f32 v37, 0, v37
    v_cvt_pk_bf16_f32 v38, 0, v38
    v_cvt_pk_bf16_f32 v39, 0, v39
    s_waitcnt vmcnt(4)
    buffer_load_dwordx4 v[88:91], v1, s[32:35], s72 offen offset:2048 nt
    v_mul_f32 v36, s74, v36
    v_mul_f32 v37, s74, v37
    v_mul_f32 v38, s74, v38
    v_mul_f32 v39, s74, v39
    v_cvt_pk_bf16_f32 v36, 0, v36
    v_cvt_pk_bf16_f32 v37, 0, v37
    v_cvt_pk_bf16_f32 v38, 0, v38
    v_cvt_pk_bf16_f32 v39, 0, v39
    v_max3_f32 v19, v36, v37, v38
    v_max_f32 v19, v19, v39
    v_cmp_gt_f32 vcc, v19, v16
    s_waitcnt vmcnt(4)
    buffer_load_dwordx4 v[92:95], v1, s[32:35], s72 offen offset:3072 nt
    s_cbranch_vccz L_skip_6
    v_mov_b32 v3, v19
    s_nop 1
    v_permlane16_swap_b32 v19, v3
    s_nop 0
    v_max_f32 v19, v19, v3
    v_mov_b32 v3, v19
    s_nop 1
    v_permlane32_swap_b32 v19, v3
    s_nop 0
    v_max3_f32 v19, v19, v3, v16
    v_sub_f32 v3, v16, v19
    v_mul_f32 v3, s75, v3
    v_exp_f32 v3, v3
    v_mov_b32 v16, v19
    v_mul_f32 v17, s76, v19
    v_mul_f32 v18, v18, v3
    v_mul_f32 v12, v12, v3
    v_mul_f32 v13, v13, v3
    v_mul_f32 v14, v14, v3
    v_mul_f32 v15, v15, v3
L_skip_6:
    v_fma_f32 v36, v36, s75, v17
    v_fma_f32 v37, v37, s75, v17
    v_fma_f32 v38, v38, s75, v17
    v_fma_f32 v39, v39, s75, v17
    v_exp_f32 v36, v36
    v_exp_f32 v37, v37
    v_exp_f32 v38, v38
    v_exp_f32 v39, v39
    s_waitcnt vmcnt(12)
    s_waitcnt lgkmcnt(0)
    v_lshlrev_b32 v44, 2, v40
    ds_read_b32 v43, v44 offset:12800
    v_add_f32 v3, v36, v37
    v_add_f32 v19, v38, v39
    v_cvt_pk_bf16_f32 v36, v36, v36
    v_cvt_pk_bf16_f32 v37, v37, v37
    v_cvt_pk_bf16_f32 v38, v38, v38
    v_cvt_pk_bf16_f32 v39, v39, v39
    v_add_f32 v3, v3, v19
    v_and_b32 v20, v36, v8
    v_and_b32 v21, v36, v9
    v_and_b32 v22, v36, v10
    v_and_b32 v23, v36, v11
    v_add_f32 v18, v18, v3
    v_and_b32 v24, v37, v8
    v_and_b32 v25, v37, v9
    v_and_b32 v26, v37, v10
    v_and_b32 v27, v37, v11
    v_mfma_f32_16x16x32_bf16 v[12:15], v[96:99], v[20:23], v[12:15]
    s_waitcnt vmcnt(4)
    buffer_load_dwordx4 v[96:99], v2, s[36:39], s72 offen offset:0 nt
    v_and_b32 v28, v38, v8
    v_and_b32 v29, v38, v9
    v_and_b32 v30, v38, v10
    v_and_b32 v31, v38, v11
    v_mfma_f32_16x16x32_bf16 v[12:15], v[100:103], v[24:27], v[12:15]
    s_waitcnt vmcnt(4)
    buffer_load_dwordx4 v[100:103], v2, s[36:39], s72 offen offset:1024 nt
    v_and_b32 v32, v39, v8
    v_and_b32 v33, v39, v9
    v_and_b32 v34, v39, v10
    v_and_b32 v35, v39, v11
    v_mfma_f32_16x16x32_bf16 v[12:15], v[104:107], v[28:31], v[12:15]
    s_waitcnt vmcnt(4)
    buffer_load_dwordx4 v[104:107], v2, s[36:39], s72 offen offset:2048 nt
    v_mfma_f32_16x16x32_bf16 v[12:15], v[108:111], v[32:35], v[12:15]
    s_waitcnt vmcnt(4)
    buffer_load_dwordx4 v[108:111], v2, s[36:39], s72 offen offset:3072 nt
    s_branch L_dloop
L_floop:
L_rt_8:
    s_waitcnt lgkmcnt(0)
    v_readfirstlane_b32 s78, v43
    s_cmp_lg_u32 s78, -1
    s_cbranch_scc1 L_tk_7
    ds_read_b32 v43, v44 offset:12800
    s_sub_u32 s77, s77, 1
    s_cbranch_scc0 L_rt_8
L_tk_7:
    s_cmp_ge_u32 s78, 0x800000
    s_cbranch_scc1 L_drain0
    s_and_b32 s72, s78, -2
L_fast0:
    s_waitcnt vmcnt(12)
    v_mfma_f32_16x16x32_bf16 v[20:23], v[48:51], v[4:7], 0
    v_mfma_f32_16x16x32_bf16 v[24:27], v[52:55], v[4:7], 0
    v_mfma_f32_16x16x32_bf16 v[28:31], v[56:59], v[4:7], 0
    v_mfma_f32_16x16x32_bf16 v[32:35], v[60:63], v[4:7], 0
    s_waitcnt vmcnt(15)
    buffer_load_dwordx4 v[48:51], v1, s[32:35], s72 offen offset:0 nt
    s_nop 2
    v_mov_b32_dpp v36, v20 quad_perm:[0,0,0,0] row_mask:0xf bank_mask:0xf
    v_mov_b32_dpp v37, v24 quad_perm:[0,0,0,0] row_mask:0xf bank_mask:0xf
    v_mov_b32_dpp v38, v28 quad_perm:[0,0,0,0] row_mask:0xf bank_mask:0xf
    v_mov_b32_dpp v39, v32 quad_perm:[0,0,0,0] row_mask:0xf bank_mask:0xf
    v_add_f32_dpp v36, v21, v36 quad_perm:[1,1,1,1] row_mask:0xf bank_mask:0xf
    v_add_f32_dpp v37, v25, v37 quad_perm:[1,1,1,1] row_mask:0xf bank_mask:0xf
    v_add_f32_dpp v38, v29, v38 quad_perm:[1,1,1,1] row_mask:0xf bank_mask:0xf
    v_add_f32_dpp v39, v33, v39 quad_perm:[1,1,1,1] row_mask:0xf bank_mask:0xf
    s_waitcnt vmcnt(15)
    buffer_load_dwordx4 v[52:55], v1, s[32:35], s72 offen offset:1024 nt
    ds_add_rtn_u32 v40, v41, v42 offset:512
    v_add_f32_dpp v36, v22, v36 quad_perm:[2,2,2,2] row_mask:0xf bank_mask:0xf
    v_add_f32_dpp v37, v26, v37 quad_perm:[2,2,2,2] row_mask:0xf bank_mask:0xf
    v_add_f32_dpp v38, v30, v38 quad_perm:[2,2,2,2] row_mask:0xf bank_mask:0xf
    v_add_f32_dpp v39, v34, v39 quad_perm:[2,2,2,2] row_mask:0xf bank_mask:0xf
    v_add_f32_dpp v36, v23, v36 quad_perm:[3,3,3,3] row_mask:0xf bank_mask:0xf
    v_add_f32_dpp v37, v27, v37 quad_perm:[3,3,3,3] row_mask:0xf bank_mask:0xf
    v_add_f32_dpp v38, v31, v38 quad_perm:[3,3,3,3] row_mask:0xf bank_mask:0xf
    v_add_f32_dpp v39, v35, v39 quad_perm:[3,3,3,3] row_mask:0xf bank_mask:0xf
    v_cvt_pk_bf16_f32 v36, 0, v36
    v_cvt_pk_bf16_f32 v37, 0, v37
    v_cvt_pk_bf16_f32 v38, 0, v38
    v_cvt_pk_bf16_f32 v39, 0, v39
    s_waitcnt vmcnt(15)
    buffer_load_dwordx4 v[56:59], v1, s[32:35], s72 offen offset:2048 nt
    v_mul_f32 v36, s74, v36
    v_mul_f32 v37, s74, v37
    v_mul_f32 v38, s74, v38
    v_mul_f32 v39, s74, v39
    v_cvt_pk_bf16_f32 v36, 0, v36
    v_cvt_pk_bf16_f32 v37, 0, v37
    v_cvt_pk_bf16_f32 v38, 0, v38
    v_cvt_pk_bf16_f32 v39, 0, v39
    v_max3_f32 v19, v36, v37, v38
    v_max_f32 v19, v19, v39
    v_cmp_gt_f32 vcc, v19, v16
    s_waitcnt vmcnt(15)
    buffer_load_dwordx4 v[60:63], v1, s[32:35], s72 offen offset:3072 nt
    s_cbranch_vccz L_skip_9
    v_mov_b32 v3, v19
    s_nop 1
    v_permlane16_swap_b32 v19, v3
    s_nop 0
    v_max_f32 v19, v19, v3
    v_mov_b32 v3, v19
    s_nop 1
    v_permlane32_swap_b32 v19, v3
    s_nop 0
    v_max3_f32 v19, v19, v3, v16
    v_sub_f32 v3, v16, v19
    v_mul_f32 v3, s75, v3
    v_exp_f32 v3, v3
    v_mov_b32 v16, v19
    v_mul_f32 v17, s76, v19
    v_mul_f32 v18, v18, v3
    v_mul_f32 v12, v12, v3
    v_mul_f32 v13, v13, v3
    v_mul_f32 v14, v14, v3
    v_mul_f32 v15, v15, v3
L_skip_9:
    v_fma_f32 v36, v36, s75, v17
    v_fma_f32 v37, v37, s75, v17
    v_fma_f32 v38, v38, s75, v17
    v_fma_f32 v39, v39, s75, v17
    v_exp_f32 v36, v36
    v_exp_f32 v37, v37
    v_exp_f32 v38, v38
    v_exp_f32 v39, v39
    s_waitcnt vmcnt(12)
    s_waitcnt lgkmcnt(0)
    v_lshlrev_b32 v44, 2, v40
    ds_read_b32 v43, v44 offset:12800
    v_add_f32 v3, v36, v37
    v_add_f32 v19, v38, v39
    v_cvt_pk_bf16_f32 v36, v36, v36
    v_cvt_pk_bf16_f32 v37, v37, v37
    v_cvt_pk_bf16_f32 v38, v38, v38
    v_cvt_pk_bf16_f32 v39, v39, v39
    v_add_f32 v3, v3, v19
    v_and_b32 v20, v36, v8
    v_and_b32 v21, v36, v9
    v_and_b32 v22, v36, v10
    v_and_b32 v23, v36, v11
    v_add_f32 v18, v18, v3
    v_and_b32 v24, v37, v8
    v_and_b32 v25, v37, v9
    v_and_b32 v26, v37, v10
    v_and_b32 v27, v37, v11
    v_mfma_f32_16x16x32_bf16 v[12:15], v[64:67], v[20:23], v[12:15]
    s_waitcnt vmcnt(15)
    buffer_load_dwordx4 v[64:67], v2, s[36:39], s72 offen offset:0 nt
    v_and_b32 v28, v38, v8
    v_and_b32 v29, v38, v9
    v_and_b32 v30, v38, v10
    v_and_b32 v31, v38, v11
    v_mfma_f32_16x16x32_bf16 v[12:15], v[68:71], v[24:27], v[12:15]
    s_waitcnt vmcnt(15)
    buffer_load_dwordx4 v[68:71], v2, s[36:39], s72 offen offset:1024 nt
    v_and_b32 v32, v39, v8
    v_and_b32 v33, v39, v9
    v_and_b32 v34, v39, v10
    v_and_b32 v35, v39, v11
    v_mfma_f32_16x16x32_bf16 v[12:15], v[72:75], v[28:31], v[12:15]
    s_waitcnt vmcnt(15)
    buffer_load_dwordx4 v[72:75], v2, s[36:39], s72 offen offset:2048 nt
    v_mfma_f32_16x16x32_bf16 v[12:15], v[76:79], v[32:35], v[12:15]
    s_waitcnt vmcnt(15)
    buffer_load_dwordx4 v[76:79], v2, s[36:39], s72 offen offset:3072 nt
L_rt_11:
    s_waitcnt lgkmcnt(0)
    v_readfirstlane_b32 s78, v43
    s_cmp_lg_u32 s78, -1
    s_cbranch_scc1 L_tk_10
    ds_read_b32 v43, v44 offset:12800
    s_sub_u32 s77, s77, 1
    s_cbranch_scc0 L_rt_11
L_tk_10:
    s_cmp_ge_u32 s78, 0x800000
    s_cbranch_scc1 L_drain1
    s_and_b32 s72, s78, -2
L_fast1:
    s_waitcnt vmcnt(12)
    v_mfma_f32_16x16x32_bf16 v[20:23], v[80:83], v[4:7], 0
    v_mfma_f32_16x16x32_bf16 v[24:27], v[84:87], v[4:7], 0
    v_mfma_f32_16x16x32_bf16 v[28:31], v[88:91], v[4:7], 0
    v_mfma_f32_16x16x32_bf16 v[32:35], v[92:95], v[4:7], 0
    s_waitcnt vmcnt(15)
    buffer_load_dwordx4 v[80:83], v1, s[32:35], s72 offen offset:0 nt
    s_nop 2
    v_mov_b32_dpp v36, v20 quad_perm:[0,0,0,0] row_mask:0xf bank_mask:0xf
    v_mov_b32_dpp v37, v24 quad_perm:[0,0,0,0] row_mask:0xf bank_mask:0xf
    v_mov_b32_dpp v38, v28 quad_perm:[0,0,0,0] row_mask:0xf bank_mask:0xf
    v_mov_b32_dpp v39, v32 quad_perm:[0,0,0,0] row_mask:0xf bank_mask:0xf
    v_add_f32_dpp v36, v21, v36 quad_perm:[1,1,1,1] row_mask:0xf bank_mask:0xf
    v_add_f32_dpp v37, v25, v37 quad_perm:[1,1,1,1] row_mask:0xf bank_mask:0xf
    v_add_f32_dpp v38, v29, v38 quad_perm:[1,1,1,1] row_mask:0xf bank_mask:0xf
    v_add_f32_dpp v39, v33, v39 quad_perm:[1,1,1,1] row_mask:0xf bank_mask:0xf
    s_waitcnt vmcnt(15)
    buffer_load_dwordx4 v[84:87], v1, s[32:35], s72 offen offset:1024 nt
    ds_add_rtn_u32 v40, v41, v42 offset:512
    v_add_f32_dpp v36, v22, v36 quad_perm:[2,2,2,2] row_mask:0xf bank_mask:0xf
    v_add_f32_dpp v37, v26, v37 quad_perm:[2,2,2,2] row_mask:0xf bank_mask:0xf
    v_add_f32_dpp v38, v30, v38 quad_perm:[2,2,2,2] row_mask:0xf bank_mask:0xf
    v_add_f32_dpp v39, v34, v39 quad_perm:[2,2,2,2] row_mask:0xf bank_mask:0xf
    v_add_f32_dpp v36, v23, v36 quad_perm:[3,3,3,3] row_mask:0xf bank_mask:0xf
    v_add_f32_dpp v37, v27, v37 quad_perm:[3,3,3,3] row_mask:0xf bank_mask:0xf
    v_add_f32_dpp v38, v31, v38 quad_perm:[3,3,3,3] row_mask:0xf bank_mask:0xf
    v_add_f32_dpp v39, v35, v39 quad_perm:[3,3,3,3] row_mask:0xf bank_mask:0xf
    v_cvt_pk_bf16_f32 v36, 0, v36
    v_cvt_pk_bf16_f32 v37, 0, v37
    v_cvt_pk_bf16_f32 v38, 0, v38
    v_cvt_pk_bf16_f32 v39, 0, v39
    s_waitcnt vmcnt(15)
    buffer_load_dwordx4 v[88:91], v1, s[32:35], s72 offen offset:2048 nt
    v_mul_f32 v36, s74, v36
    v_mul_f32 v37, s74, v37
    v_mul_f32 v38, s74, v38
    v_mul_f32 v39, s74, v39
    v_cvt_pk_bf16_f32 v36, 0, v36
    v_cvt_pk_bf16_f32 v37, 0, v37
    v_cvt_pk_bf16_f32 v38, 0, v38
    v_cvt_pk_bf16_f32 v39, 0, v39
    v_max3_f32 v19, v36, v37, v38
    v_max_f32 v19, v19, v39
    v_cmp_gt_f32 vcc, v19, v16
    s_waitcnt vmcnt(15)
    buffer_load_dwordx4 v[92:95], v1, s[32:35], s72 offen offset:3072 nt
    s_cbranch_vccz L_skip_12
    v_mov_b32 v3, v19
    s_nop 1
    v_permlane16_swap_b32 v19, v3
    s_nop 0
    v_max_f32 v19, v19, v3
    v_mov_b32 v3, v19
    s_nop 1
    v_permlane32_swap_b32 v19, v3
    s_nop 0
    v_max3_f32 v19, v19, v3, v16
    v_sub_f32 v3, v16, v19
    v_mul_f32 v3, s75, v3
    v_exp_f32 v3, v3
    v_mov_b32 v16, v19
    v_mul_f32 v17, s76, v19
    v_mul_f32 v18, v18, v3
    v_mul_f32 v12, v12, v3
    v_mul_f32 v13, v13, v3
    v_mul_f32 v14, v14, v3
    v_mul_f32 v15, v15, v3
L_skip_12:
    v_fma_f32 v36, v36, s75, v17
    v_fma_f32 v37, v37, s75, v17
    v_fma_f32 v38, v38, s75, v17
    v_fma_f32 v39, v39, s75, v17
    v_exp_f32 v36, v36
    v_exp_f32 v37, v37
    v_exp_f32 v38, v38
    v_exp_f32 v39, v39
    s_waitcnt vmcnt(12)
    s_waitcnt lgkmcnt(0)
    v_lshlrev_b32 v44, 2, v40
    ds_read_b32 v43, v44 offset:12800
    v_add_f32 v3, v36, v37
    v_add_f32 v19, v38, v39
    v_cvt_pk_bf16_f32 v36, v36, v36
    v_cvt_pk_bf16_f32 v37, v37, v37
    v_cvt_pk_bf16_f32 v38, v38, v38
    v_cvt_pk_bf16_f32 v39, v39, v39
    v_add_f32 v3, v3, v19
    v_and_b32 v20, v36, v8
    v_and_b32 v21, v36, v9
    v_and_b32 v22, v36, v10
    v_and_b32 v23, v36, v11
    v_add_f32 v18, v18, v3
    v_and_b32 v24, v37, v8
    v_and_b32 v25, v37, v9
    v_and_b32 v26, v37, v10
    v_and_b32 v27, v37, v11
    v_mfma_f32_16x16x32_bf16 v[12:15], v[96:99], v[20:23], v[12:15]
    s_waitcnt vmcnt(15)
    buffer_load_dwordx4 v[96:99], v2, s[36:39], s72 offen offset:0 nt
    v_and_b32 v28, v38, v8
    v_and_b32 v29, v38, v9
    v_and_b32 v30, v38, v10
    v_and_b32 v31, v38, v11
    v_mfma_f32_16x16x32_bf16 v[12:15], v[100:103], v[24:27], v[12:15]
    s_waitcnt vmcnt(15)
    buffer_load_dwordx4 v[100:103], v2, s[36:39], s72 offen offset:1024 nt
    v_and_b32 v32, v39, v8
    v_and_b32 v33, v39, v9
    v_and_b32 v34, v39, v10
    v_and_b32 v35, v39, v11
    v_mfma_f32_16x16x32_bf16 v[12:15], v[104:107], v[28:31], v[12:15]
    s_waitcnt vmcnt(15)
    buffer_load_dwordx4 v[104:107], v2, s[36:39], s72 offen offset:2048 nt
    v_mfma_f32_16x16x32_bf16 v[12:15], v[108:111], v[32:35], v[12:15]
    s_waitcnt vmcnt(15)
    buffer_load_dwordx4 v[108:111], v2, s[36:39], s72 offen offset:3072 nt
    s_branch L_floop
L_drain1:
    s_waitcnt vmcnt(12)
    v_mfma_f32_16x16x32_bf16 v[20:23], v[80:83], v[4:7], 0
    v_mfma_f32_16x16x32_bf16 v[24:27], v[84:87], v[4:7], 0
    v_mfma_f32_16x16x32_bf16 v[28:31], v[88:91], v[4:7], 0
    v_mfma_f32_16x16x32_bf16 v[32:35], v[92:95], v[4:7], 0
    s_nop 4
    v_mov_b32_dpp v36, v20 quad_perm:[0,0,0,0] row_mask:0xf bank_mask:0xf
    v_mov_b32_dpp v37, v24 quad_perm:[0,0,0,0] row_mask:0xf bank_mask:0xf
    v_mov_b32_dpp v38, v28 quad_perm:[0,0,0,0] row_mask:0xf bank_mask:0xf
    v_mov_b32_dpp v39, v32 quad_perm:[0,0,0,0] row_mask:0xf bank_mask:0xf
    v_add_f32_dpp v36, v21, v36 quad_perm:[1,1,1,1] row_mask:0xf bank_mask:0xf
    v_add_f32_dpp v37, v25, v37 quad_perm:[1,1,1,1] row_mask:0xf bank_mask:0xf
    v_add_f32_dpp v38, v29, v38 quad_perm:[1,1,1,1] row_mask:0xf bank_mask:0xf
    v_add_f32_dpp v39, v33, v39 quad_perm:[1,1,1,1] row_mask:0xf bank_mask:0xf
    v_add_f32_dpp v36, v22, v36 quad_perm:[2,2,2,2] row_mask:0xf bank_mask:0xf
    v_add_f32_dpp v37, v26, v37 quad_perm:[2,2,2,2] row_mask:0xf bank_mask:0xf
    v_add_f32_dpp v38, v30, v38 quad_perm:[2,2,2,2] row_mask:0xf bank_mask:0xf
    v_add_f32_dpp v39, v34, v39 quad_perm:[2,2,2,2] row_mask:0xf bank_mask:0xf
    v_add_f32_dpp v36, v23, v36 quad_perm:[3,3,3,3] row_mask:0xf bank_mask:0xf
    v_add_f32_dpp v37, v27, v37 quad_perm:[3,3,3,3] row_mask:0xf bank_mask:0xf
    v_add_f32_dpp v38, v31, v38 quad_perm:[3,3,3,3] row_mask:0xf bank_mask:0xf
    v_add_f32_dpp v39, v35, v39 quad_perm:[3,3,3,3] row_mask:0xf bank_mask:0xf
    v_cvt_pk_bf16_f32 v36, 0, v36
    v_cvt_pk_bf16_f32 v37, 0, v37
    v_cvt_pk_bf16_f32 v38, 0, v38
    v_cvt_pk_bf16_f32 v39, 0, v39
    v_mul_f32 v36, s74, v36
    v_mul_f32 v37, s74, v37
    v_mul_f32 v38, s74, v38
    v_mul_f32 v39, s74, v39
    v_cvt_pk_bf16_f32 v36, 0, v36
    v_cvt_pk_bf16_f32 v37, 0, v37
    v_cvt_pk_bf16_f32 v38, 0, v38
    v_cvt_pk_bf16_f32 v39, 0, v39
    v_max3_f32 v19, v36, v37, v38
    v_max_f32 v19, v19, v39
    v_cmp_gt_f32 vcc, v19, v16
    s_nop 1
    s_cbranch_vccz L_skip_13
    v_mov_b32 v3, v19
    s_nop 1
    v_permlane16_swap_b32 v19, v3
    s_nop 0
    v_max_f32 v19, v19, v3
    v_mov_b32 v3, v19
    s_nop 1
    v_permlane32_swap_b32 v19, v3
    s_nop 0
    v_max3_f32 v19, v19, v3, v16
    v_sub_f32 v3, v16, v19
    v_mul_f32 v3, s75, v3
    v_exp_f32 v3, v3
    v_mov_b32 v16, v19
    v_mul_f32 v17, s76, v19
    v_mul_f32 v18, v18, v3
    v_mul_f32 v12, v12, v3
    v_mul_f32 v13, v13, v3
    v_mul_f32 v14, v14, v3
    v_mul_f32 v15, v15, v3
L_skip_13:
    v_fma_f32 v36, v36, s75, v17
    v_fma_f32 v37, v37, s75, v17
    v_fma_f32 v38, v38, s75, v17
    v_fma_f32 v39, v39, s75, v17
    v_exp_f32 v36, v36
    v_exp_f32 v37, v37
    v_exp_f32 v38, v38
    v_exp_f32 v39, v39
    s_waitcnt vmcnt(8)
    v_add_f32 v3, v36, v37
    v_add_f32 v19, v38, v39
    v_cvt_pk_bf16_f32 v36, v36, v36
    v_cvt_pk_bf16_f32 v37, v37, v37
    v_cvt_pk_bf16_f32 v38, v38, v38
    v_cvt_pk_bf16_f32 v39, v39, v39
    v_add_f32 v3, v3, v19
    v_and_b32 v20, v36, v8
    v_and_b32 v21, v36, v9
    v_and_b32 v22, v36, v10
    v_and_b32 v23, v36, v11
    v_add_f32 v18, v18, v3
    v_and_b32 v24, v37, v8
    v_and_b32 v25, v37, v9
    v_and_b32 v26, v37, v10
    v_and_b32 v27, v37, v11
    v_mfma_f32_16x16x32_bf16 v[12:15], v[96:99], v[20:23], v[12:15]
    v_and_b32 v28, v38, v8
    v_and_b32 v29, v38, v9
    v_and_b32 v30, v38, v10
    v_and_b32 v31, v38, v11
    v_mfma_f32_16x16x32_bf16 v[12:15], v[100:103], v[24:27], v[12:15]
    v_and_b32 v32, v39, v8
    v_and_b32 v33, v39, v9
    v_and_b32 v34, v39, v10
    v_and_b32 v35, v39, v11
    v_mfma_f32_16x16x32_bf16 v[12:15], v[104:107], v[28:31], v[12:15]
    s_nop 0
    v_mfma_f32_16x16x32_bf16 v[12:15], v[108:111], v[32:35], v[12:15]
    s_waitcnt vmcnt(4)
    v_mfma_f32_16x16x32_bf16 v[20:23], v[48:51], v[4:7], 0
    v_mfma_f32_16x16x32_bf16 v[24:27], v[52:55], v[4:7], 0
    v_mfma_f32_16x16x32_bf16 v[28:31], v[56:59], v[4:7], 0
    v_mfma_f32_16x16x32_bf16 v[32:35], v[60:63], v[4:7], 0
    s_nop 4
    v_mov_b32_dpp v36, v20 quad_perm:[0,0,0,0] row_mask:0xf bank_mask:0xf
    v_mov_b32_dpp v37, v24 quad_perm:[0,0,0,0] row_mask:0xf bank_mask:0xf
    v_mov_b32_dpp v38, v28 quad_perm:[0,0,0,0] row_mask:0xf bank_mask:0xf
    v_mov_b32_dpp v39, v32 quad_perm:[0,0,0,0] row_mask:0xf bank_mask:0xf
    v_add_f32_dpp v36, v21, v36 quad_perm:[1,1,1,1] row_mask:0xf bank_mask:0xf
    v_add_f32_dpp v37, v25, v37 quad_perm:[1,1,1,1] row_mask:0xf bank_mask:0xf
    v_add_f32_dpp v38, v29, v38 quad_perm:[1,1,1,1] row_mask:0xf bank_mask:0xf
    v_add_f32_dpp v39, v33, v39 quad_perm:[1,1,1,1] row_mask:0xf bank_mask:0xf
    v_add_f32_dpp v36, v22, v36 quad_perm:[2,2,2,2] row_mask:0xf bank_mask:0xf
    v_add_f32_dpp v37, v26, v37 quad_perm:[2,2,2,2] row_mask:0xf bank_mask:0xf
    v_add_f32_dpp v38, v30, v38 quad_perm:[2,2,2,2] row_mask:0xf bank_mask:0xf
    v_add_f32_dpp v39, v34, v39 quad_perm:[2,2,2,2] row_mask:0xf bank_mask:0xf
    v_add_f32_dpp v36, v23, v36 quad_perm:[3,3,3,3] row_mask:0xf bank_mask:0xf
    v_add_f32_dpp v37, v27, v37 quad_perm:[3,3,3,3] row_mask:0xf bank_mask:0xf
    v_add_f32_dpp v38, v31, v38 quad_perm:[3,3,3,3] row_mask:0xf bank_mask:0xf
    v_add_f32_dpp v39, v35, v39 quad_perm:[3,3,3,3] row_mask:0xf bank_mask:0xf
    v_cvt_pk_bf16_f32 v36, 0, v36
    v_cvt_pk_bf16_f32 v37, 0, v37
    v_cvt_pk_bf16_f32 v38, 0, v38
    v_cvt_pk_bf16_f32 v39, 0, v39
    v_mul_f32 v36, s74, v36
    v_mul_f32 v37, s74, v37
    v_mul_f32 v38, s74, v38
    v_mul_f32 v39, s74, v39
    v_cvt_pk_bf16_f32 v36, 0, v36
    v_cvt_pk_bf16_f32 v37, 0, v37
    v_cvt_pk_bf16_f32 v38, 0, v38
    v_cvt_pk_bf16_f32 v39, 0, v39
    v_max3_f32 v19, v36, v37, v38
    v_max_f32 v19, v19, v39
    v_cmp_gt_f32 vcc, v19, v16
    s_nop 1
    s_cbranch_vccz L_skip_14
    v_mov_b32 v3, v19
    s_nop 1
    v_permlane16_swap_b32 v19, v3
    s_nop 0
    v_max_f32 v19, v19, v3
    v_mov_b32 v3, v19
    s_nop 1
    v_permlane32_swap_b32 v19, v3
    s_nop 0
    v_max3_f32 v19, v19, v3, v16
    v_sub_f32 v3, v16, v19
    v_mul_f32 v3, s75, v3
    v_exp_f32 v3, v3
    v_mov_b32 v16, v19
    v_mul_f32 v17, s76, v19
    v_mul_f32 v18, v18, v3
    v_mul_f32 v12, v12, v3
    v_mul_f32 v13, v13, v3
    v_mul_f32 v14, v14, v3
    v_mul_f32 v15, v15, v3
L_skip_14:
    v_fma_f32 v36, v36, s75, v17
    v_fma_f32 v37, v37, s75, v17
    v_fma_f32 v38, v38, s75, v17
    v_fma_f32 v39, v39, s75, v17
    v_exp_f32 v36, v36
    v_exp_f32 v37, v37
    v_exp_f32 v38, v38
    v_exp_f32 v39, v39
    s_waitcnt vmcnt(0)
    v_add_f32 v3, v36, v37
    v_add_f32 v19, v38, v39
    v_cvt_pk_bf16_f32 v36, v36, v36
    v_cvt_pk_bf16_f32 v37, v37, v37
    v_cvt_pk_bf16_f32 v38, v38, v38
    v_cvt_pk_bf16_f32 v39, v39, v39
    v_add_f32 v3, v3, v19
    v_and_b32 v20, v36, v8
    v_and_b32 v21, v36, v9
    v_and_b32 v22, v36, v10
    v_and_b32 v23, v36, v11
    v_add_f32 v18, v18, v3
    v_and_b32 v24, v37, v8
    v_and_b32 v25, v37, v9
    v_and_b32 v26, v37, v10
    v_and_b32 v27, v37, v11
    v_mfma_f32_16x16x32_bf16 v[12:15], v[64:67], v[20:23], v[12:15]
    v_and_b32 v28, v38, v8
    v_and_b32 v29, v38, v9
    v_and_b32 v30, v38, v10
    v_and_b32 v31, v38, v11
    v_mfma_f32_16x16x32_bf16 v[12:15], v[68:71], v[24:27], v[12:15]
    v_and_b32 v32, v39, v8
    v_and_b32 v33, v39, v9
    v_and_b32 v34, v39, v10
    v_and_b32 v35, v39, v11
    v_mfma_f32_16x16x32_bf16 v[12:15], v[72:75], v[28:31], v[12:15]
    s_nop 0
    v_mfma_f32_16x16x32_bf16 v[12:15], v[76:79], v[32:35], v[12:15]
    s_branch L_sdone
L_drain0:
    s_waitcnt vmcnt(12)
    v_mfma_f32_16x16x32_bf16 v[20:23], v[48:51], v[4:7], 0
    v_mfma_f32_16x16x32_bf16 v[24:27], v[52:55], v[4:7], 0
    v_mfma_f32_16x16x32_bf16 v[28:31], v[56:59], v[4:7], 0
    v_mfma_f32_16x16x32_bf16 v[32:35], v[60:63], v[4:7], 0
    s_nop 4
    v_mov_b32_dpp v36, v20 quad_perm:[0,0,0,0] row_mask:0xf bank_mask:0xf
    v_mov_b32_dpp v37, v24 quad_perm:[0,0,0,0] row_mask:0xf bank_mask:0xf
    v_mov_b32_dpp v38, v28 quad_perm:[0,0,0,0] row_mask:0xf bank_mask:0xf
    v_mov_b32_dpp v39, v32 quad_perm:[0,0,0,0] row_mask:0xf bank_mask:0xf
    v_add_f32_dpp v36, v21, v36 quad_perm:[1,1,1,1] row_mask:0xf bank_mask:0xf
    v_add_f32_dpp v37, v25, v37 quad_perm:[1,1,1,1] row_mask:0xf bank_mask:0xf
    v_add_f32_dpp v38, v29, v38 quad_perm:[1,1,1,1] row_mask:0xf bank_mask:0xf
    v_add_f32_dpp v39, v33, v39 quad_perm:[1,1,1,1] row_mask:0xf bank_mask:0xf
    v_add_f32_dpp v36, v22, v36 quad_perm:[2,2,2,2] row_mask:0xf bank_mask:0xf
    v_add_f32_dpp v37, v26, v37 quad_perm:[2,2,2,2] row_mask:0xf bank_mask:0xf
    v_add_f32_dpp v38, v30, v38 quad_perm:[2,2,2,2] row_mask:0xf bank_mask:0xf
    v_add_f32_dpp v39, v34, v39 quad_perm:[2,2,2,2] row_mask:0xf bank_mask:0xf
    v_add_f32_dpp v36, v23, v36 quad_perm:[3,3,3,3] row_mask:0xf bank_mask:0xf
    v_add_f32_dpp v37, v27, v37 quad_perm:[3,3,3,3] row_mask:0xf bank_mask:0xf
    v_add_f32_dpp v38, v31, v38 quad_perm:[3,3,3,3] row_mask:0xf bank_mask:0xf
    v_add_f32_dpp v39, v35, v39 quad_perm:[3,3,3,3] row_mask:0xf bank_mask:0xf
    v_cvt_pk_bf16_f32 v36, 0, v36
    v_cvt_pk_bf16_f32 v37, 0, v37
    v_cvt_pk_bf16_f32 v38, 0, v38
    v_cvt_pk_bf16_f32 v39, 0, v39
    v_mul_f32 v36, s74, v36
    v_mul_f32 v37, s74, v37
    v_mul_f32 v38, s74, v38
    v_mul_f32 v39, s74, v39
    v_cvt_pk_bf16_f32 v36, 0, v36
    v_cvt_pk_bf16_f32 v37, 0, v37
    v_cvt_pk_bf16_f32 v38, 0, v38
    v_cvt_pk_bf16_f32 v39, 0, v39
    v_max3_f32 v19, v36, v37, v38
    v_max_f32 v19, v19, v39
    v_cmp_gt_f32 vcc, v19, v16
    s_nop 1
    s_cbranch_vccz L_skip_15
    v_mov_b32 v3, v19
    s_nop 1
    v_permlane16_swap_b32 v19, v3
    s_nop 0
    v_max_f32 v19, v19, v3
    v_mov_b32 v3, v19
    s_nop 1
    v_permlane32_swap_b32 v19, v3
    s_nop 0
    v_max3_f32 v19, v19, v3, v16
    v_sub_f32 v3, v16, v19
    v_mul_f32 v3, s75, v3
    v_exp_f32 v3, v3
    v_mov_b32 v16, v19
    v_mul_f32 v17, s76, v19
    v_mul_f32 v18, v18, v3
    v_mul_f32 v12, v12, v3
    v_mul_f32 v13, v13, v3
    v_mul_f32 v14, v14, v3
    v_mul_f32 v15, v15, v3
L_skip_15:
    v_fma_f32 v36, v36, s75, v17
    v_fma_f32 v37, v37, s75, v17
    v_fma_f32 v38, v38, s75, v17
    v_fma_f32 v39, v39, s75, v17
    v_exp_f32 v36, v36
    v_exp_f32 v37, v37
    v_exp_f32 v38, v38
    v_exp_f32 v39, v39
    s_waitcnt vmcnt(8)
    v_add_f32 v3, v36, v37
    v_add_f32 v19, v38, v39
    v_cvt_pk_bf16_f32 v36, v36, v36
    v_cvt_pk_bf16_f32 v37, v37, v37
    v_cvt_pk_bf16_f32 v38, v38, v38
    v_cvt_pk_bf16_f32 v39, v39, v39
    v_add_f32 v3, v3, v19
    v_and_b32 v20, v36, v8
    v_and_b32 v21, v36, v9
    v_and_b32 v22, v36, v10
    v_and_b32 v23, v36, v11
    v_add_f32 v18, v18, v3
    v_and_b32 v24, v37, v8
    v_and_b32 v25, v37, v9
    v_and_b32 v26, v37, v10
    v_and_b32 v27, v37, v11
    v_mfma_f32_16x16x32_bf16 v[12:15], v[64:67], v[20:23], v[12:15]
    v_and_b32 v28, v38, v8
    v_and_b32 v29, v38, v9
    v_and_b32 v30, v38, v10
    v_and_b32 v31, v38, v11
    v_mfma_f32_16x16x32_bf16 v[12:15], v[68:71], v[24:27], v[12:15]
    v_and_b32 v32, v39, v8
    v_and_b32 v33, v39, v9
    v_and_b32 v34, v39, v10
    v_and_b32 v35, v39, v11
    v_mfma_f32_16x16x32_bf16 v[12:15], v[72:75], v[28:31], v[12:15]
    s_nop 0
    v_mfma_f32_16x16x32_bf16 v[12:15], v[76:79], v[32:35], v[12:15]
    s_waitcnt vmcnt(4)
    v_mfma_f32_16x16x32_bf16 v[20:23], v[80:83], v[4:7], 0
    v_mfma_f32_16x16x32_bf16 v[24:27], v[84:87], v[4:7], 0
    v_mfma_f32_16x16x32_bf16 v[28:31], v[88:91], v[4:7], 0
    v_mfma_f32_16x16x32_bf16 v[32:35], v[92:95], v[4:7], 0
    s_nop 4
    v_mov_b32_dpp v36, v20 quad_perm:[0,0,0,0] row_mask:0xf bank_mask:0xf
    v_mov_b32_dpp v37, v24 quad_perm:[0,0,0,0] row_mask:0xf bank_mask:0xf
    v_mov_b32_dpp v38, v28 quad_perm:[0,0,0,0] row_mask:0xf bank_mask:0xf
    v_mov_b32_dpp v39, v32 quad_perm:[0,0,0,0] row_mask:0xf bank_mask:0xf
    v_add_f32_dpp v36, v21, v36 quad_perm:[1,1,1,1] row_mask:0xf bank_mask:0xf
    v_add_f32_dpp v37, v25, v37 quad_perm:[1,1,1,1] row_mask:0xf bank_mask:0xf
    v_add_f32_dpp v38, v29, v38 quad_perm:[1,1,1,1] row_mask:0xf bank_mask:0xf
    v_add_f32_dpp v39, v33, v39 quad_perm:[1,1,1,1] row_mask:0xf bank_mask:0xf
    v_add_f32_dpp v36, v22, v36 quad_perm:[2,2,2,2] row_mask:0xf bank_mask:0xf
    v_add_f32_dpp v37, v26, v37 quad_perm:[2,2,2,2] row_mask:0xf bank_mask:0xf
    v_add_f32_dpp v38, v30, v38 quad_perm:[2,2,2,2] row_mask:0xf bank_mask:0xf
    v_add_f32_dpp v39, v34, v39 quad_perm:[2,2,2,2] row_mask:0xf bank_mask:0xf
    v_add_f32_dpp v36, v23, v36 quad_perm:[3,3,3,3] row_mask:0xf bank_mask:0xf
    v_add_f32_dpp v37, v27, v37 quad_perm:[3,3,3,3] row_mask:0xf bank_mask:0xf
    v_add_f32_dpp v38, v31, v38 quad_perm:[3,3,3,3] row_mask:0xf bank_mask:0xf
    v_add_f32_dpp v39, v35, v39 quad_perm:[3,3,3,3] row_mask:0xf bank_mask:0xf
    v_cvt_pk_bf16_f32 v36, 0, v36
    v_cvt_pk_bf16_f32 v37, 0, v37
    v_cvt_pk_bf16_f32 v38, 0, v38
    v_cvt_pk_bf16_f32 v39, 0, v39
    v_mul_f32 v36, s74, v36
    v_mul_f32 v37, s74, v37
    v_mul_f32 v38, s74, v38
    v_mul_f32 v39, s74, v39
    v_cvt_pk_bf16_f32 v36, 0, v36
    v_cvt_pk_bf16_f32 v37, 0, v37
    v_cvt_pk_bf16_f32 v38, 0, v38
    v_cvt_pk_bf16_f32 v39, 0, v39
    v_max3_f32 v19, v36, v37, v38
    v_max_f32 v19, v19, v39
    v_cmp_gt_f32 vcc, v19, v16
    s_nop 1
    s_cbranch_vccz L_skip_16
    v_mov_b32 v3, v19
    s_nop 1
    v_permlane16_swap_b32 v19, v3
    s_nop 0
    v_max_f32 v19, v19, v3
    v_mov_b32 v3, v19
    s_nop 1
    v_permlane32_swap_b32 v19, v3
    s_nop 0
    v_max3_f32 v19, v19, v3, v16
    v_sub_f32 v3, v16, v19
    v_mul_f32 v3, s75, v3
    v_exp_f32 v3, v3
    v_mov_b32 v16, v19
    v_mul_f32 v17, s76, v19
    v_mul_f32 v18, v18, v3
    v_mul_f32 v12, v12, v3
    v_mul_f32 v13, v13, v3
    v_mul_f32 v14, v14, v3
    v_mul_f32 v15, v15, v3
L_skip_16:
    v_fma_f32 v36, v36, s75, v17
    v_fma_f32 v37, v37, s75, v17
    v_fma_f32 v38, v38, s75, v17
    v_fma_f32 v39, v39, s75, v17
    v_exp_f32 v36, v36
    v_exp_f32 v37, v37
    v_exp_f32 v38, v38
    v_exp_f32 v39, v39
    s_waitcnt vmcnt(0)
    v_add_f32 v3, v36, v37
    v_add_f32 v19, v38, v39
    v_cvt_pk_bf16_f32 v36, v36, v36
    v_cvt_pk_bf16_f32 v37, v37, v37
    v_cvt_pk_bf16_f32 v38, v38, v38
    v_cvt_pk_bf16_f32 v39, v39, v39
    v_add_f32 v3, v3, v19
    v_and_b32 v20, v36, v8
    v_and_b32 v21, v36, v9
    v_and_b32 v22, v36, v10
    v_and_b32 v23, v36, v11
    v_add_f32 v18, v18, v3
    v_and_b32 v24, v37, v8
    v_and_b32 v25, v37, v9
    v_and_b32 v26, v37, v10
    v_and_b32 v27, v37, v11
    v_mfma_f32_16x16x32_bf16 v[12:15], v[96:99], v[20:23], v[12:15]
    v_and_b32 v28, v38, v8
    v_and_b32 v29, v38, v9
    v_and_b32 v30, v38, v10
    v_and_b32 v31, v38, v11
    v_mfma_f32_16x16x32_bf16 v[12:15], v[100:103], v[24:27], v[12:15]
    v_and_b32 v32, v39, v8
    v_and_b32 v33, v39, v9
    v_and_b32 v34, v39, v10
    v_and_b32 v35, v39, v11
    v_mfma_f32_16x16x32_bf16 v[12:15], v[104:107], v[28:31], v[12:15]
    s_nop 0
    v_mfma_f32_16x16x32_bf16 v[12:15], v[108:111], v[32:35], v[12:15]
L_sdone:
    v_mov_b32 v3, v18
    s_nop 1
    v_permlane16_swap_b32 v18, v3
    s_nop 0
    v_add_f32 v18, v18, v3
    v_mov_b32 v3, v18
    s_nop 1
    v_permlane32_swap_b32 v18, v3
    s_nop 0
    v_add_f32 v17, v18, v3
    s_lshl_b32 s72, s3, 10
    v_add_u32 v20, s72, v2
    v_lshrrev_b32 v21, 1, v20
    ds_write_b128 v20, v[12:15] offset:1024
    ds_write_b64 v21, v[16:17] offset:5120
    s_add_u32 s83, s84, 1
    s_and_b32 s84, s83, 0xff
    s_mov_b32 s85, 0xffffff00
    v_mov_b32 v45, s84
    s_waitcnt vmcnt(0) lgkmcnt(0)
    s_barrier
    s_cmp_eq_u32 s3, 0
    s_cbranch_scc1 L_combine
L_after:
    s_cmp_lt_u32 s2, 72
    s_cbranch_scc1 L_reduce
L_endst:
    s_endpgm
L_combine:
    v_lshrrev_b32 v21, 1, v2
    ds_read_b64 v[64:65], v21 offset:5120
    ds_read_b64 v[66:67], v21 offset:5632
    ds_read_b64 v[68:69], v21 offset:6144
    ds_read_b64 v[70:71], v21 offset:6656
    ds_read_b128 v[48:51], v2 offset:1024
    ds_read_b128 v[52:55], v2 offset:2048
    ds_read_b128 v[56:59], v2 offset:3072
    ds_read_b128 v[60:63], v2 offset:4096
    v_bfe_u32 v26, v0, 3, 1
    v_lshlrev_b32 v24, 12, v26
    v_lshlrev_b32 v25, 12, v26
    v_lshrrev_b32 v26, 4, v0
    v_lshl_add_u32 v24, v26, 7, v24
    v_and_b32 v26, 7, v0
    v_lshl_add_u32 v24, v26, 4, v24
    v_and_b32 v26, 0x37, v0
    v_cmp_eq_u32 vcc, 0, v26
    v_mov_b32 v26, 0x80000000
    s_lshr_b32 s80, s2, 3
    s_lshl_b32 s80, s80, 4
    s_and_b32 s81, s2, 7
    s_add_u32 s81, s80, s81
    v_cndmask_b32 v25, v26, v25, vcc
    s_lshl_b32 s80, s81, 9
    s_add_u32 s80, s80, 0x40000
    s_lshl_b32 s81, s2, 4
    s_add_u32 s81, s81, 0x80000
    v_mov_b32 v74, s83
    v_mov_b32 v75, s83
    s_waitcnt lgkmcnt(4)
    v_max3_f32 v72, v64, v66, v68
    v_max_f32 v72, v72, v70
    v_sub_f32 v64, v64, v72
    v_sub_f32 v66, v66, v72
    v_sub_f32 v68, v68, v72
    v_sub_f32 v70, v70, v72
    v_mul_f32 v64, s75, v64
    v_mul_f32 v66, s75, v66
    v_mul_f32 v68, s75, v68
    v_mul_f32 v70, s75, v70
    v_exp_f32 v64, v64
    v_exp_f32 v66, v66
    v_exp_f32 v68, v68
    v_exp_f32 v70, v70
    s_waitcnt lgkmcnt(0)
    v_mul_f32 v73, v64, v65
    v_mul_f32 v76, v64, v48
    v_mul_f32 v77, v64, v49
    v_mul_f32 v78, v64, v50
    v_mul_f32 v79, v64, v51
    v_fmac_f32 v73, v66, v67
    v_fmac_f32 v76, v66, v52
    v_fmac_f32 v77, v66, v53
    v_fmac_f32 v78, v66, v54
    v_fmac_f32 v79, v66, v55
    v_fmac_f32 v73, v68, v69
    v_fmac_f32 v76, v68, v56
    v_fmac_f32 v77, v68, v57
    v_fmac_f32 v78, v68, v58
    v_fmac_f32 v79, v68, v59
    v_fmac_f32 v73, v70, v71
    v_fmac_f32 v76, v70, v60
    v_fmac_f32 v77, v70, v61
    v_fmac_f32 v78, v70, v62
    v_fmac_f32 v79, v70, v63
    v_and_or_b32 v76, v76, s85, v45
    v_and_or_b32 v77, v77, s85, v45
    v_and_or_b32 v78, v78, s85, v45
    v_and_or_b32 v79, v79, s85, v45
    v_and_or_b32 v72, v72, s85, v45
    v_and_or_b32 v73, v73, s85, v45
    buffer_store_dwordx4 v[76:79], v24, s[68:71], s80 offen sc1
    buffer_store_dwordx4 v[72:75], v25, s[68:71], s81 offen sc1
    s_branch L_after
L_reduce:
    s_mov_b32 s28, s4
    s_mov_b32 s29, s5
    s_mov_b32 s30, 0x900
    s_mov_b32 s31, 0x20000
    s_mov_b32 s60, s22
    s_mov_b32 s61, s23
    s_mov_b32 s62, 0x900
    s_mov_b32 s63, 0x20000
    s_cmp_ge_u32 s2, 36
    s_cselect_b32 s72, 36, 0
    s_cselect_b32 s73, 576, 0
    s_sub_u32 s72, s2, s72
    s_lshr_b32 s77, s72, 1
    s_lshl_b32 s77, s77, 5
    s_and_b32 s72, s72, 1
    s_lshl_b32 s72, s72, 2
    s_add_u32 s72, s72, s77
    s_add_u32 s72, s72, s73
    s_lshl_b32 s72, s72, 1
    v_lshrrev_b32 v20, 2, v0
    v_lshlrev_b32 v20, 4, v20
    v_and_b32 v21, 3, v0
    v_lshl_add_u32 v20, v21, 1, v20
    v_add_u32 v20, s72, v20
    v_mov_b32 v21, 0x80000000
    v_cmp_gt_u32 vcc, 16, v0
    s_nop 1
    v_cndmask_b32 v20, v21, v20, vcc
    buffer_load_ushort v22, v20, s[28:31], 0 offen
    s_lshl_b32 s73, s2, 14
    s_lshl_b32 s77, s3, 12
    s_add_u32 s73, s73, s77
    s_add_u32 s73, s73, 0x100000
    s_mov_b32 s82, 262144
    v_and_b32 v23, 15, v0
    v_lshlrev_b32 v23, 2, v23
    s_lshl_b32 s77, s3, 6
    v_add_u32 v26, s77, v23
    buffer_load_dwordx4 v[96:99], v2, s[68:71], s73 offen offset:0 sc1
    buffer_load_dwordx4 v[100:103], v2, s[68:71], s73 offen offset:1024 sc1
    buffer_load_dwordx4 v[104:107], v2, s[68:71], s73 offen offset:2048 sc1
    buffer_load_dwordx4 v[108:111], v2, s[68:71], s73 offen offset:3072 sc1
    s_barrier
    buffer_load_dwordx4 v[80:83], v2, s[68:71], s73 offen offset:0 sc1
    buffer_load_dwordx4 v[84:87], v2, s[68:71], s73 offen offset:1024 sc1
    buffer_load_dwordx4 v[88:91], v2, s[68:71], s73 offen offset:2048 sc1
    buffer_load_dwordx4 v[92:95], v2, s[68:71], s73 offen offset:3072 sc1
    s_sleep 10
L_rpoll:
    buffer_load_dwordx4 v[96:99], v2, s[68:71], s73 offen offset:0 sc1
    buffer_load_dwordx4 v[100:103], v2, s[68:71], s73 offen offset:1024 sc1
    buffer_load_dwordx4 v[104:107], v2, s[68:71], s73 offen offset:2048 sc1
    buffer_load_dwordx4 v[108:111], v2, s[68:71], s73 offen offset:3072 sc1
    s_waitcnt vmcnt(4)
    v_xor_b32 v80, v45, v80
    v_xor_b32 v81, v45, v81
    v_xor_b32 v82, v45, v82
    v_xor_b32 v83, v45, v83
    v_xor_b32 v84, v45, v84
    v_xor_b32 v85, v45, v85
    v_xor_b32 v86, v45, v86
    v_xor_b32 v87, v45, v87
    v_xor_b32 v88, v45, v88
    v_xor_b32 v89, v45, v89
    v_xor_b32 v90, v45, v90
    v_xor_b32 v91, v45, v91
    v_xor_b32 v92, v45, v92
    v_xor_b32 v93, v45, v93
    v_xor_b32 v94, v45, v94
    v_xor_b32 v95, v45, v95
    v_or3_b32 v24, v80, v81, v82
    v_or3_b32 v25, v83, v84, v85
    v_or3_b32 v24, v24, v86, v87
    v_or3_b32 v25, v25, v88, v89
    v_or3_b32 v24, v24, v90, v91
    v_or3_b32 v25, v25, v92, v93
    v_or3_b32 v24, v24, v94, v95
    v_or_b32 v24, v24, v25
    v_and_b32 v24, 0xff, v24
    v_cmp_ne_u32 vcc, 0, v24
    v_add_f32 v28, v80, v84
    v_add_f32 v32, v88, v92
    v_add_f32 v29, v81, v85
    v_add_f32 v33, v89, v93
    v_add_f32 v30, v82, v86
    v_add_f32 v34, v90, v94
    v_add_f32 v31, v83, v87
    v_add_f32 v35, v91, v95
    s_cbranch_vccz L_rdone
    buffer_load_dwordx4 v[80:83], v2, s[68:71], s73 offen offset:0 sc1
    buffer_load_dwordx4 v[84:87], v2, s[68:71], s73 offen offset:1024 sc1
    buffer_load_dwordx4 v[88:91], v2, s[68:71], s73 offen offset:2048 sc1
    buffer_load_dwordx4 v[92:95], v2, s[68:71], s73 offen offset:3072 sc1
    s_waitcnt vmcnt(4)
    v_xor_b32 v96, v45, v96
    v_xor_b32 v97, v45, v97
    v_xor_b32 v98, v45, v98
    v_xor_b32 v99, v45, v99
    v_xor_b32 v100, v45, v100
    v_xor_b32 v101, v45, v101
    v_xor_b32 v102, v45, v102
    v_xor_b32 v103, v45, v103
    v_xor_b32 v104, v45, v104
    v_xor_b32 v105, v45, v105
    v_xor_b32 v106, v45, v106
    v_xor_b32 v107, v45, v107
    v_xor_b32 v108, v45, v108
    v_xor_b32 v109, v45, v109
    v_xor_b32 v110, v45, v110
    v_xor_b32 v111, v45, v111
    v_or3_b32 v24, v96, v97, v98
    v_or3_b32 v25, v99, v100, v101
    v_or3_b32 v24, v24, v102, v103
    v_or3_b32 v25, v25, v104, v105
    v_or3_b32 v24, v24, v106, v107
    v_or3_b32 v25, v25, v108, v109
    v_or3_b32 v24, v24, v110, v111
    v_or_b32 v24, v24, v25
    v_and_b32 v24, 0xff, v24
    v_cmp_ne_u32 vcc, 0, v24
    v_add_f32 v28, v96, v100
    v_add_f32 v32, v104, v108
    v_add_f32 v29, v97, v101
    v_add_f32 v33, v105, v109
    v_add_f32 v30, v98, v102
    v_add_f32 v34, v106, v110
    v_add_f32 v31, v99, v103
    v_add_f32 v35, v107, v111
    s_cbranch_vccz L_rdone
    s_sub_u32 s82, s82, 1
    s_cbranch_scc0 L_rpoll
L_rdone:
    v_add_f32 v28, v28, v32
    v_add_f32 v29, v29, v33
    v_add_f32 v30, v30, v34
    v_add_f32 v31, v31, v35
    v_add_f32_dpp v28, v28, v28 row_ror:4 row_mask:0xf bank_mask:0xf
    v_add_f32_dpp v29, v29, v29 row_ror:4 row_mask:0xf bank_mask:0xf
    v_add_f32_dpp v30, v30, v30 row_ror:4 row_mask:0xf bank_mask:0xf
    v_add_f32_dpp v31, v31, v31 row_ror:4 row_mask:0xf bank_mask:0xf
    v_add_f32_dpp v28, v28, v28 row_ror:8 row_mask:0xf bank_mask:0xf
    v_add_f32_dpp v29, v29, v29 row_ror:8 row_mask:0xf bank_mask:0xf
    v_add_f32_dpp v30, v30, v30 row_ror:8 row_mask:0xf bank_mask:0xf
    v_add_f32_dpp v31, v31, v31 row_ror:8 row_mask:0xf bank_mask:0xf
    s_nop 0
    s_nop 1
    v_mov_b32_dpp v24, v28 quad_perm:[0,1,2,3] row_mask:0xf bank_mask:0x1
    s_nop 1
    v_mov_b32_dpp v24, v29 quad_perm:[0,1,2,3] row_mask:0xf bank_mask:0x2
    s_nop 1
    v_mov_b32_dpp v24, v30 quad_perm:[0,1,2,3] row_mask:0xf bank_mask:0x4
    s_nop 1
    v_mov_b32_dpp v24, v31 quad_perm:[0,1,2,3] row_mask:0xf bank_mask:0x8
    v_mov_b32 v3, v24
    s_nop 1
    v_permlane16_swap_b32 v24, v3
    s_nop 0
    v_add_f32 v24, v24, v3
    v_mov_b32 v3, v24
    s_nop 1
    v_permlane32_swap_b32 v24, v3
    s_nop 0
    v_add_f32 v24, v24, v3
    ds_write_b32 v26, v24 offset:0
    s_waitcnt lgkmcnt(0)
    s_barrier
    s_cmp_lg_u32 s3, 1
    s_cbranch_scc1 L_rend
    ds_read2_b32 v[28:29], v23 offset0:0 offset1:16
    ds_read2_b32 v[30:31], v23 offset0:32 offset1:48
    v_lshlrev_b32 v22, 16, v22
    s_waitcnt lgkmcnt(0)
    v_add_f32 v28, v28, v29
    v_add_f32 v30, v30, v31
    v_add_f32 v24, v28, v30
    v_add_f32 v24, v24, v22
    v_cvt_pk_bf16_f32 v24, v24, v24
    buffer_store_short v24, v20, s[60:63], 0 offen
    s_cmp_lg_u32 s2, 0
    s_cbranch_scc1 L_rend
    v_mov_b32 v25, s83
    s_mov_b32 s82, 0xc0000
    buffer_store_dword v25, off, s[68:71], s82
L_rend:
    s_endpgm
L_s0:
    s_setprio 3
    v_mul_u32_u24 v1, 36, v0
    s_and_b32 s72, s2, 7
    s_lshr_b32 s73, s2, 3
    s_mul_i32 s74, s72, 144
    v_bfe_u32 v3, v0, 3, 1
    v_mul_u32_u24 v2, 1152, v3
    v_lshrrev_b32 v3, 4, v0
    v_mul_u32_u24 v13, 36, v3
    v_add3_u32 v2, v2, v13, s74
    v_mul_u32_u24 v3, 147456, v3
    v_and_b32 v13, 15, v0
    v_lshl_add_u32 v3, v13, 4, v3
    s_mul_i32 s74, s72, 589824
    s_lshl_b32 s75, s73, 8
    s_add_u32 s74, s74, s75
    s_waitcnt lgkmcnt(0)
    s_mov_b32 s28, s4
    s_mov_b32 s29, s5
    s_mov_b32 s30, 0x900
    s_mov_b32 s31, 0x20000
    buffer_load_dwordx4 v[4:7], v1, s[28:31], 0 offen
    buffer_load_dwordx4 v[8:11], v1, s[28:31], 0 offen offset:16
    buffer_load_dword v12, v1, s[28:31], 0 offen offset:32
    buffer_load_dwordx4 v[16:19], v2, s[28:31], 0 offen
    buffer_load_dwordx4 v[20:23], v2, s[28:31], 0 offen offset:16
    buffer_load_dword v24, v2, s[28:31], 0 offen offset:32
    s_load_dword s84, s[26:27], 0xc0000
    s_mov_b32 s40, s10
    s_mov_b32 s41, s11
    s_mov_b32 s42, 0x480000
    s_mov_b32 s43, 0x20000
    buffer_load_dwordx4 v[64:67], v3, s[40:43], s74 offen nt
    s_add_u32 s74, s74, 8192
    buffer_load_dwordx4 v[68:71], v3, s[40:43], s74 offen nt
    s_add_u32 s74, s74, 8192
    buffer_load_dwordx4 v[72:75], v3, s[40:43], s74 offen nt
    s_add_u32 s74, s74, 8192
    buffer_load_dwordx4 v[76:79], v3, s[40:43], s74 offen nt
    s_add_u32 s74, s74, 8192
    buffer_load_dwordx4 v[80:83], v3, s[40:43], s74 offen nt
    s_add_u32 s74, s74, 8192
    buffer_load_dwordx4 v[84:87], v3, s[40:43], s74 offen nt
    s_add_u32 s74, s74, 8192
    buffer_load_dwordx4 v[88:91], v3, s[40:43], s74 offen nt
    s_add_u32 s74, s74, 8192
    buffer_load_dwordx4 v[92:95], v3, s[40:43], s74 offen nt
    s_add_u32 s74, s74, 8192
    buffer_load_dwordx4 v[96:99], v3, s[40:43], s74 offen nt
    s_add_u32 s74, s74, 8192
    buffer_load_dwordx4 v[100:103], v3, s[40:43], s74 offen nt
    s_add_u32 s74, s74, 8192
    buffer_load_dwordx4 v[104:107], v3, s[40:43], s74 offen nt
    s_add_u32 s74, s74, 8192
    buffer_load_dwordx4 v[108:111], v3, s[40:43], s74 offen nt
    s_add_u32 s74, s74, 8192
    buffer_load_dwordx4 v[112:115], v3, s[40:43], s74 offen nt
    s_add_u32 s74, s74, 8192
    buffer_load_dwordx4 v[116:119], v3, s[40:43], s74 offen nt
    s_add_u32 s74, s74, 8192
    buffer_load_dwordx4 v[120:123], v3, s[40:43], s74 offen nt
    s_add_u32 s74, s74, 8192
    buffer_load_dwordx4 v[124:127], v3, s[40:43], s74 offen nt
    s_add_u32 s74, s74, 8192
    buffer_load_dwordx4 v[128:131], v3, s[40:43], s74 offen nt
    s_add_u32 s74, s74, 8192
    buffer_load_dwordx4 v[132:135], v3, s[40:43], s74 offen nt
    s_mov_b32 s68, s26
    s_mov_b32 s69, s27
    s_mov_b32 s70, 0x300000
    s_mov_b32 s71, 0x20000
    s_and_b32 s80, s2, 15
    s_cmp_lt_u32 s80, 2
    s_cselect_b32 s81, 1, 0
    s_and_b32 s80, s2, 1
    s_lshl_b32 s80, s80, 4
    s_lshr_b32 s83, s2, 4
    s_add_u32 s80, s80, s83
    s_lshl_b32 s80, s80, 10
    s_add_u32 s80, s80, 0xd0000
    v_cmp_gt_u32 vcc, s81, v0
    v_mov_b32 v147, 1856
    v_mov_b32 v146, 0x80000000
    v_cndmask_b32 v146, v146, 0, vcc
    buffer_store_dword v147, v146, s[68:71], s80 offen sc1
    v_bfe_u32 v144, v0, 3, 1
    v_lshlrev_b32 v140, 12, v144
    v_lshlrev_b32 v141, 12, v144
    v_lshrrev_b32 v144, 4, v0
    v_lshl_add_u32 v140, v144, 7, v140
    v_and_b32 v144, 7, v0
    v_lshl_add_u32 v140, v144, 4, v140
    v_and_b32 v144, 0x37, v0
    v_cmp_eq_u32 vcc, 0, v144
    v_mov_b32 v144, 0x80000000
    s_lshr_b32 s80, s2, 3
    s_lshl_b32 s80, s80, 4
    s_and_b32 s81, s2, 7
    s_add_u32 s81, s80, s81
    v_cndmask_b32 v141, v144, v141, vcc
    s_lshl_b32 s80, s81, 9
    s_add_u32 s80, s80, 0x40000
    s_lshl_b32 s81, s2, 4
    s_add_u32 s81, s81, 0x80000
    v_lshlrev_b32 v142, 2, v0
    v_mov_b32 v143, 0
    ds_write_b32 v142, v143 offset:512
    ds_write_b32 v142, v143 offset:768
    v_mov_b32 v148, -1
    v_mov_b32 v149, -1
    v_mov_b32 v150, -1
    v_mov_b32 v151, -1
    v_lshlrev_b32 v143, 4, v0
    ds_write_b128 v143, v[148:151] offset:12800
    ds_write_b128 v143, v[148:151] offset:13824
    ds_write_b128 v143, v[148:151] offset:14848
    ds_write_b128 v143, v[148:151] offset:15872
    s_waitcnt lgkmcnt(0)
    s_barrier
    v_and_b32 v144, 1, v0
    v_cmp_eq_u32 vcc, 1, v144
    v_mov_b32 v144, 0xffff
    v_mov_b32 v145, 0xffff0000
    v_cndmask_b32 v144, v144, v145, vcc
    v_bfe_u32 v145, v0, 1, 2
    v_cmp_eq_u32 vcc, 0, v145
    s_nop 1
    v_cndmask_b32 v152, 0, v144, vcc
    v_cmp_eq_u32 vcc, 1, v145
    s_nop 1
    v_cndmask_b32 v153, 0, v144, vcc
    v_cmp_eq_u32 vcc, 2, v145
    s_nop 1
    v_cndmask_b32 v154, 0, v144, vcc
    v_cmp_eq_u32 vcc, 3, v145
    s_nop 1
    v_cndmask_b32 v155, 0, v144, vcc
    s_waitcnt vmcnt(22)
    v_lshlrev_b32 v28, 16, v4
    v_and_b32 v29, 0xffff0000, v4
    v_lshlrev_b32 v30, 16, v5
    v_and_b32 v31, 0xffff0000, v5
    v_lshlrev_b32 v32, 16, v6
    v_and_b32 v33, 0xffff0000, v6
    v_lshlrev_b32 v34, 16, v7
    v_and_b32 v35, 0xffff0000, v7
    v_lshlrev_b32 v36, 16, v8
    v_and_b32 v37, 0xffff0000, v8
    v_lshlrev_b32 v38, 16, v9
    v_and_b32 v39, 0xffff0000, v9
    v_lshlrev_b32 v40, 16, v10
    v_and_b32 v41, 0xffff0000, v10
    v_lshlrev_b32 v42, 16, v11
    v_and_b32 v43, 0xffff0000, v11
    v_lshlrev_b32 v44, 16, v12
    v_and_b32 v45, 0xffff0000, v12
    v_add_f32 v46, v28, v29
    v_add_f32 v48, v30, v31
    v_add_f32 v46, v46, v32
    v_add_f32 v48, v48, v33
    v_add_f32 v46, v46, v34
    v_add_f32 v48, v48, v35
    v_add_f32 v46, v46, v36
    v_add_f32 v48, v48, v37
    v_add_f32 v46, v46, v38
    v_add_f32 v48, v48, v39
    v_add_f32 v46, v46, v40
    v_add_f32 v48, v48, v41
    v_add_f32 v46, v46, v42
    v_add_f32 v48, v48, v43
    v_add_f32 v46, v46, v44
    v_add_f32 v48, v48, v45
    v_add_f32 v46, v46, v48
    s_nop 1
    v_add_f32_dpp v46, v46, v46 quad_perm:[1,0,3,2] row_mask:0xf bank_mask:0xf
    s_nop 1
    v_add_f32_dpp v46, v46, v46 quad_perm:[2,3,0,1] row_mask:0xf bank_mask:0xf
    s_nop 1
    v_add_f32_dpp v46, v46, v46 row_half_mirror row_mask:0xf bank_mask:0xf
    s_nop 1
    v_add_f32_dpp v46, v46, v46 row_mirror row_mask:0xf bank_mask:0xf
    v_mov_b32 v48, v46
    s_nop 1
    v_permlane16_swap_b32 v46, v48
    s_nop 0
    v_add_f32 v46, v46, v48
    v_mul_f32 v46, 0x3ae38e39, v46
    v_sub_f32 v48, v28, v46
    v_sub_f32 v49, v29, v46
    v_mul_f32 v47, v48, v48
    v_mul_f32 v50, v49, v49
    v_sub_f32 v48, v30, v46
    v_sub_f32 v49, v31, v46
    v_fmac_f32 v47, v48, v48
    v_fmac_f32 v50, v49, v49
    v_sub_f32 v48, v32, v46
    v_sub_f32 v49, v33, v46
    v_fmac_f32 v47, v48, v48
    v_fmac_f32 v50, v49, v49
    v_sub_f32 v48, v34, v46
    v_sub_f32 v49, v35, v46
    v_fmac_f32 v47, v48, v48
    v_fmac_f32 v50, v49, v49
    v_sub_f32 v48, v36, v46
    v_sub_f32 v49, v37, v46
    v_fmac_f32 v47, v48, v48
    v_fmac_f32 v50, v49, v49
    v_sub_f32 v48, v38, v46
    v_sub_f32 v49, v39, v46
    v_fmac_f32 v47, v48, v48
    v_fmac_f32 v50, v49, v49
    v_sub_f32 v48, v40, v46
    v_sub_f32 v49, v41, v46
    v_fmac_f32 v47, v48, v48
    v_fmac_f32 v50, v49, v49
    v_sub_f32 v48, v42, v46
    v_sub_f32 v49, v43, v46
    v_fmac_f32 v47, v48, v48
    v_fmac_f32 v50, v49, v49
    v_sub_f32 v48, v44, v46
    v_sub_f32 v49, v45, v46
    v_fmac_f32 v47, v48, v48
    v_fmac_f32 v50, v49, v49
    v_add_f32 v47, v47, v50
    s_nop 1
    v_add_f32_dpp v47, v47, v47 quad_perm:[1,0,3,2] row_mask:0xf bank_mask:0xf
    s_nop 1
    v_add_f32_dpp v47, v47, v47 quad_perm:[2,3,0,1] row_mask:0xf bank_mask:0xf
    s_nop 1
    v_add_f32_dpp v47, v47, v47 row_half_mirror row_mask:0xf bank_mask:0xf
    s_nop 1
    v_add_f32_dpp v47, v47, v47 row_mirror row_mask:0xf bank_mask:0xf
    v_mov_b32 v48, v47
    s_nop 1
    v_permlane16_swap_b32 v47, v48
    s_nop 0
    v_add_f32 v47, v47, v48
    v_mul_f32 v47, 0x3ae38e39, v47
    v_cvt_pk_bf16_f32 v46, 0, v46
    v_cvt_pk_bf16_f32 v47, 0, v47
    v_add_f32 v47, 0x3727c5ac, v47
    v_cvt_pk_bf16_f32 v47, 0, v47
    v_sqrt_f32 v47, v47
    s_nop 0
    v_cvt_pk_bf16_f32 v47, 0, v47
    s_nop 0
    v_readlane_b32 s76, v46, 0
    v_readlane_b32 s77, v46, 32
    v_readlane_b32 s78, v47, 0
    v_readlane_b32 s79, v47, 32
    v_and_b32 v48, 8, v0
    v_cmp_eq_u32 vcc, 0, v48
    v_mov_b32 v46, s77
    v_mov_b32 v48, s76
    v_mov_b32 v47, s79
    v_mov_b32 v49, s78
    v_cndmask_b32 v46, v46, v48, vcc
    v_cndmask_b32 v47, v47, v49, vcc
    v_rcp_f32 v48, v47
    s_waitcnt vmcnt(19)
    v_lshlrev_b32 v28, 16, v16
    v_and_b32 v29, 0xffff0000, v16
    v_lshlrev_b32 v30, 16, v17
    v_and_b32 v31, 0xffff0000, v17
    v_lshlrev_b32 v32, 16, v18
    v_and_b32 v33, 0xffff0000, v18
    v_lshlrev_b32 v34, 16, v19
    v_and_b32 v35, 0xffff0000, v19
    v_lshlrev_b32 v36, 16, v20
    v_and_b32 v37, 0xffff0000, v20
    v_lshlrev_b32 v38, 16, v21
    v_and_b32 v39, 0xffff0000, v21
    v_lshlrev_b32 v40, 16, v22
    v_and_b32 v41, 0xffff0000, v22
    v_lshlrev_b32 v42, 16, v23
    v_and_b32 v43, 0xffff0000, v23
    v_lshlrev_b32 v44, 16, v24
    v_and_b32 v45, 0xffff0000, v24
    v_sub_f32 v28, v28, v46
    v_cvt_pk_bf16_f32 v28, 0, v28
    v_mul_f32 v49, v28, v48
    v_fma_f32 v28, -v49, v47, v28
    v_fma_f32 v28, v28, v48, v49
    v_sub_f32 v29, v29, v46
    v_cvt_pk_bf16_f32 v29, 0, v29
    v_mul_f32 v50, v29, v48
    v_fma_f32 v29, -v50, v47, v29
    v_fma_f32 v29, v29, v48, v50
    v_sub_f32 v30, v30, v46
    v_cvt_pk_bf16_f32 v30, 0, v30
    v_mul_f32 v49, v30, v48
    v_fma_f32 v30, -v49, v47, v30
    v_fma_f32 v30, v30, v48, v49
    v_sub_f32 v31, v31, v46
    v_cvt_pk_bf16_f32 v31, 0, v31
    v_mul_f32 v50, v31, v48
    v_fma_f32 v31, -v50, v47, v31
    v_fma_f32 v31, v31, v48, v50
    v_sub_f32 v32, v32, v46
    v_cvt_pk_bf16_f32 v32, 0, v32
    v_mul_f32 v49, v32, v48
    v_fma_f32 v32, -v49, v47, v32
    v_fma_f32 v32, v32, v48, v49
    v_sub_f32 v33, v33, v46
    v_cvt_pk_bf16_f32 v33, 0, v33
    v_mul_f32 v50, v33, v48
    v_fma_f32 v33, -v50, v47, v33
    v_fma_f32 v33, v33, v48, v50
    v_sub_f32 v34, v34, v46
    v_cvt_pk_bf16_f32 v34, 0, v34
    v_mul_f32 v49, v34, v48
    v_fma_f32 v34, -v49, v47, v34
    v_fma_f32 v34, v34, v48, v49
    v_sub_f32 v35, v35, v46
    v_cvt_pk_bf16_f32 v35, 0, v35
    v_mul_f32 v50, v35, v48
    v_fma_f32 v35, -v50, v47, v35
    v_fma_f32 v35, v35, v48, v50
    v_sub_f32 v36, v36, v46
    v_cvt_pk_bf16_f32 v36, 0, v36
    v_mul_f32 v49, v36, v48
    v_fma_f32 v36, -v49, v47, v36
    v_fma_f32 v36, v36, v48, v49
    v_sub_f32 v37, v37, v46
    v_cvt_pk_bf16_f32 v37, 0, v37
    v_mul_f32 v50, v37, v48
    v_fma_f32 v37, -v50, v47, v37
    v_fma_f32 v37, v37, v48, v50
    v_sub_f32 v38, v38, v46
    v_cvt_pk_bf16_f32 v38, 0, v38
    v_mul_f32 v49, v38, v48
    v_fma_f32 v38, -v49, v47, v38
    v_fma_f32 v38, v38, v48, v49
    v_sub_f32 v39, v39, v46
    v_cvt_pk_bf16_f32 v39, 0, v39
    v_mul_f32 v50, v39, v48
    v_fma_f32 v39, -v50, v47, v39
    v_fma_f32 v39, v39, v48, v50
    v_sub_f32 v40, v40, v46
    v_cvt_pk_bf16_f32 v40, 0, v40
    v_mul_f32 v49, v40, v48
    v_fma_f32 v40, -v49, v47, v40
    v_fma_f32 v40, v40, v48, v49
    v_sub_f32 v41, v41, v46
    v_cvt_pk_bf16_f32 v41, 0, v41
    v_mul_f32 v50, v41, v48
    v_fma_f32 v41, -v50, v47, v41
    v_fma_f32 v41, v41, v48, v50
    v_sub_f32 v42, v42, v46
    v_cvt_pk_bf16_f32 v42, 0, v42
    v_mul_f32 v49, v42, v48
    v_fma_f32 v42, -v49, v47, v42
    v_fma_f32 v42, v42, v48, v49
    v_sub_f32 v43, v43, v46
    v_cvt_pk_bf16_f32 v43, 0, v43
    v_mul_f32 v50, v43, v48
    v_fma_f32 v43, -v50, v47, v43
    v_fma_f32 v43, v43, v48, v50
    v_sub_f32 v44, v44, v46
    v_cvt_pk_bf16_f32 v44, 0, v44
    v_mul_f32 v49, v44, v48
    v_fma_f32 v44, -v49, v47, v44
    v_fma_f32 v44, v44, v48, v49
    v_sub_f32 v45, v45, v46
    v_cvt_pk_bf16_f32 v45, 0, v45
    v_mul_f32 v50, v45, v48
    v_fma_f32 v45, -v50, v47, v45
    v_fma_f32 v45, v45, v48, v50
    v_cvt_pk_bf16_f32 v28, v28, v28
    v_cvt_pk_bf16_f32 v29, v29, v29
    v_cvt_pk_bf16_f32 v30, v30, v30
    v_cvt_pk_bf16_f32 v31, v31, v31
    v_cvt_pk_bf16_f32 v32, v32, v32
    v_cvt_pk_bf16_f32 v33, v33, v33
    v_cvt_pk_bf16_f32 v34, v34, v34
    v_cvt_pk_bf16_f32 v35, v35, v35
    v_cvt_pk_bf16_f32 v36, v36, v36
    v_cvt_pk_bf16_f32 v37, v37, v37
    v_cvt_pk_bf16_f32 v38, v38, v38
    v_cvt_pk_bf16_f32 v39, v39, v39
    v_cvt_pk_bf16_f32 v40, v40, v40
    v_cvt_pk_bf16_f32 v41, v41, v41
    v_cvt_pk_bf16_f32 v42, v42, v42
    v_cvt_pk_bf16_f32 v43, v43, v43
    v_cvt_pk_bf16_f32 v44, v44, v44
    v_cvt_pk_bf16_f32 v45, v45, v45
    v_and_b32 v52, v28, v152
    v_and_b32 v53, v28, v153
    v_and_b32 v54, v28, v154
    v_and_b32 v55, v28, v155
    v_and_b32 v56, v29, v152
    v_and_b32 v57, v29, v153
    v_and_b32 v58, v29, v154
    v_and_b32 v59, v29, v155
    s_waitcnt vmcnt(18)
    v_mfma_f32_16x16x32_bf16 v[60:63], v[64:67], v[52:55], 0
    v_and_b32 v52, v30, v152
    v_and_b32 v53, v30, v153
    v_and_b32 v54, v30, v154
    v_and_b32 v55, v30, v155
    s_waitcnt vmcnt(17)
    v_mfma_f32_16x16x32_bf16 v[60:63], v[68:71], v[56:59], v[60:63]
    v_and_b32 v56, v31, v152
    v_and_b32 v57, v31, v153
    v_and_b32 v58, v31, v154
    v_and_b32 v59, v31, v155
    s_waitcnt vmcnt(16)
    v_mfma_f32_16x16x32_bf16 v[60:63], v[72:75], v[52:55], v[60:63]
    v_and_b32 v52, v32, v152
    v_and_b32 v53, v32, v153
    v_and_b32 v54, v32, v154
    v_and_b32 v55, v32, v155
    s_waitcnt vmcnt(15)
    v_mfma_f32_16x16x32_bf16 v[60:63], v[76:79], v[56:59], v[60:63]
    v_and_b32 v56, v33, v152
    v_and_b32 v57, v33, v153
    v_and_b32 v58, v33, v154
    v_and_b32 v59, v33, v155
    s_waitcnt vmcnt(14)
    v_mfma_f32_16x16x32_bf16 v[60:63], v[80:83], v[52:55], v[60:63]
    v_and_b32 v52, v34, v152
    v_and_b32 v53, v34, v153
    v_and_b32 v54, v34, v154
    v_and_b32 v55, v34, v155
    s_waitcnt vmcnt(13)
    v_mfma_f32_16x16x32_bf16 v[60:63], v[84:87], v[56:59], v[60:63]
    v_and_b32 v56, v35, v152
    v_and_b32 v57, v35, v153
    v_and_b32 v58, v35, v154
    v_and_b32 v59, v35, v155
    s_waitcnt vmcnt(12)
    v_mfma_f32_16x16x32_bf16 v[60:63], v[88:91], v[52:55], v[60:63]
    v_and_b32 v52, v36, v152
    v_and_b32 v53, v36, v153
    v_and_b32 v54, v36, v154
    v_and_b32 v55, v36, v155
    s_waitcnt vmcnt(11)
    v_mfma_f32_16x16x32_bf16 v[60:63], v[92:95], v[56:59], v[60:63]
    v_and_b32 v56, v37, v152
    v_and_b32 v57, v37, v153
    v_and_b32 v58, v37, v154
    v_and_b32 v59, v37, v155
    s_waitcnt vmcnt(10)
    v_mfma_f32_16x16x32_bf16 v[60:63], v[96:99], v[52:55], v[60:63]
    v_and_b32 v52, v38, v152
    v_and_b32 v53, v38, v153
    v_and_b32 v54, v38, v154
    v_and_b32 v55, v38, v155
    s_waitcnt vmcnt(9)
    v_mfma_f32_16x16x32_bf16 v[60:63], v[100:103], v[56:59], v[60:63]
    v_and_b32 v56, v39, v152
    v_and_b32 v57, v39, v153
    v_and_b32 v58, v39, v154
    v_and_b32 v59, v39, v155
    s_waitcnt vmcnt(8)
    v_mfma_f32_16x16x32_bf16 v[60:63], v[104:107], v[52:55], v[60:63]
    v_and_b32 v52, v40, v152
    v_and_b32 v53, v40, v153
    v_and_b32 v54, v40, v154
    v_and_b32 v55, v40, v155
    s_waitcnt vmcnt(7)
    v_mfma_f32_16x16x32_bf16 v[60:63], v[108:111], v[56:59], v[60:63]
    v_and_b32 v56, v41, v152
    v_and_b32 v57, v41, v153
    v_and_b32 v58, v41, v154
    v_and_b32 v59, v41, v155
    s_waitcnt vmcnt(6)
    v_mfma_f32_16x16x32_bf16 v[60:63], v[112:115], v[52:55], v[60:63]
    v_and_b32 v52, v42, v152
    v_and_b32 v53, v42, v153
    v_and_b32 v54, v42, v154
    v_and_b32 v55, v42, v155
    s_waitcnt vmcnt(5)
    v_mfma_f32_16x16x32_bf16 v[60:63], v[116:119], v[56:59], v[60:63]
    v_and_b32 v56, v43, v152
    v_and_b32 v57, v43, v153
    v_and_b32 v58, v43, v154
    v_and_b32 v59, v43, v155
    s_waitcnt vmcnt(4)
    v_mfma_f32_16x16x32_bf16 v[60:63], v[120:123], v[52:55], v[60:63]
    v_and_b32 v52, v44, v152
    v_and_b32 v53, v44, v153
    v_and_b32 v54, v44, v154
    v_and_b32 v55, v44, v155
    s_waitcnt vmcnt(3)
    v_mfma_f32_16x16x32_bf16 v[60:63], v[124:127], v[56:59], v[60:63]
    v_and_b32 v56, v45, v152
    v_and_b32 v57, v45, v153
    v_and_b32 v58, v45, v154
    v_and_b32 v59, v45, v155
    s_waitcnt vmcnt(2)
    v_mfma_f32_16x16x32_bf16 v[60:63], v[128:131], v[52:55], v[60:63]
    s_waitcnt vmcnt(0)
    v_mfma_f32_16x16x32_bf16 v[60:63], v[132:135], v[56:59], v[60:63]
    s_lshl_b32 s74, s73, 13
    s_lshl_b32 s75, s72, 9
    s_add_u32 s74, s74, s75
    s_add_u32 s74, s74, 0x0
    s_nop 1
    s_and_b32 s75, s73, 15
    s_lshl_b32 s76, s75, 4
    s_lshl_b32 s77, s75, 14
    s_lshr_b32 s78, s2, 7
    s_lshl_b32 s78, s78, 12
    s_add_u32 s77, s77, s78
    s_add_u32 s77, s77, 0x0
    s_waitcnt lgkmcnt(0)
    s_add_u32 s84, s84, 1
    s_and_b32 s84, s84, 0xf
    s_mov_b32 s85, 0xfffffff0
    v_mov_b32 v9, s84
    v_add_u32 v60, 8, v60
    v_add_u32 v61, 8, v61
    v_add_u32 v62, 8, v62
    v_add_u32 v63, 8, v63
    v_and_or_b32 v60, v60, s85, v9
    v_and_or_b32 v61, v61, s85, v9
    v_and_or_b32 v62, v62, s85, v9
    v_and_or_b32 v63, v63, s85, v9
    buffer_store_dwordx4 v[60:63], v140, s[68:71], s74 offen sc1
    v_lshrrev_b32 v6, 5, v0
    v_lshlrev_b32 v7, 13, v6
    v_and_b32 v8, 31, v0
    v_lshl_add_u32 v7, v8, 4, v7
    v_lshlrev_b32 v6, 8, v6
    v_bfe_u32 v8, v0, 3, 2
    v_lshl_add_u32 v6, v8, 6, v6
    v_and_b32 v8, 7, v0
    v_lshl_add_u32 v6, v8, 1, v6
    s_mov_b32 s82, 262144
    v_mov_b32 v4, 0
L_qg:
    s_sleep 4
    ds_read_b32 v5, v4 offset:788
    s_sub_u32 s82, s82, 1
    s_cbranch_scc1 L_qdone
    s_waitcnt lgkmcnt(0)
    v_readfirstlane_b32 s76, v5
    s_cmp_lt_u32 s76, 4
    s_cbranch_scc1 L_qg
L_qpoll:
    buffer_load_dwordx4 v[64:67], v7, s[68:71], s77 offen offset:0 sc1
    buffer_load_dwordx4 v[68:71], v7, s[68:71], s77 offen offset:512 sc1
    buffer_load_dwordx4 v[72:75], v7, s[68:71], s77 offen offset:1024 sc1
    buffer_load_dwordx4 v[76:79], v7, s[68:71], s77 offen offset:1536 sc1
    buffer_load_dwordx4 v[80:83], v7, s[68:71], s77 offen offset:2048 sc1
    buffer_load_dwordx4 v[84:87], v7, s[68:71], s77 offen offset:2560 sc1
    buffer_load_dwordx4 v[88:91], v7, s[68:71], s77 offen offset:3072 sc1
    buffer_load_dwordx4 v[92:95], v7, s[68:71], s77 offen offset:3584 sc1
    s_waitcnt vmcnt(7)
    v_xor_b32 v64, v9, v64
    v_xor_b32 v65, v9, v65
    v_xor_b32 v66, v9, v66
    v_xor_b32 v67, v9, v67
    v_or_b32 v12, v64, v65
    v_or_b32 v13, v66, v67
    s_waitcnt vmcnt(6)
    v_xor_b32 v68, v9, v68
    v_xor_b32 v69, v9, v69
    v_xor_b32 v70, v9, v70
    v_xor_b32 v71, v9, v71
    v_or3_b32 v12, v12, v68, v69
    v_or3_b32 v13, v13, v70, v71
    v_add_f32 v64, v64, v68
    v_add_f32 v65, v65, v69
    v_add_f32 v66, v66, v70
    v_add_f32 v67, v67, v71
    s_waitcnt vmcnt(5)
    v_xor_b32 v72, v9, v72
    v_xor_b32 v73, v9, v73
    v_xor_b32 v74, v9, v74
    v_xor_b32 v75, v9, v75
    v_or3_b32 v12, v12, v72, v73
    v_or3_b32 v13, v13, v74, v75
    v_add_f32 v64, v64, v72
    v_add_f32 v65, v65, v73
    v_add_f32 v66, v66, v74
    v_add_f32 v67, v67, v75
    s_waitcnt vmcnt(4)
    v_xor_b32 v76, v9, v76
    v_xor_b32 v77, v9, v77
    v_xor_b32 v78, v9, v78
    v_xor_b32 v79, v9, v79
    v_or3_b32 v12, v12, v76, v77
    v_or3_b32 v13, v13, v78, v79
    v_add_f32 v64, v64, v76
    v_add_f32 v65, v65, v77
    v_add_f32 v66, v66, v78
    v_add_f32 v67, v67, v79
    s_waitcnt vmcnt(3)
    v_xor_b32 v80, v9, v80
    v_xor_b32 v81, v9, v81
    v_xor_b32 v82, v9, v82
    v_xor_b32 v83, v9, v83
    v_or3_b32 v12, v12, v80, v81
    v_or3_b32 v13, v13, v82, v83
    v_add_f32 v64, v64, v80
    v_add_f32 v65, v65, v81
    v_add_f32 v66, v66, v82
    v_add_f32 v67, v67, v83
    s_waitcnt vmcnt(2)
    v_xor_b32 v84, v9, v84
    v_xor_b32 v85, v9, v85
    v_xor_b32 v86, v9, v86
    v_xor_b32 v87, v9, v87
    v_or3_b32 v12, v12, v84, v85
    v_or3_b32 v13, v13, v86, v87
    v_add_f32 v64, v64, v84
    v_add_f32 v65, v65, v85
    v_add_f32 v66, v66, v86
    v_add_f32 v67, v67, v87
    s_waitcnt vmcnt(1)
    v_xor_b32 v88, v9, v88
    v_xor_b32 v89, v9, v89
    v_xor_b32 v90, v9, v90
    v_xor_b32 v91, v9, v91
    v_or3_b32 v12, v12, v88, v89
    v_or3_b32 v13, v13, v90, v91
    v_add_f32 v64, v64, v88
    v_add_f32 v65, v65, v89
    v_add_f32 v66, v66, v90
    v_add_f32 v67, v67, v91
    s_waitcnt vmcnt(0)
    v_xor_b32 v92, v9, v92
    v_xor_b32 v93, v9, v93
    v_xor_b32 v94, v9, v94
    v_xor_b32 v95, v9, v95
    v_or3_b32 v12, v12, v92, v93
    v_or3_b32 v13, v13, v94, v95
    v_add_f32 v64, v64, v92
    v_add_f32 v65, v65, v93
    v_add_f32 v66, v66, v94
    v_add_f32 v67, v67, v95
    v_or_b32 v12, v12, v13
    v_and_b32 v12, 0xf, v12
    v_cmp_ne_u32 vcc, 0, v12
    s_sub_u32 s82, s82, 1
    s_cbranch_scc1 L_qdone
    s_cbranch_vccz L_qdone
    s_sleep 16
    s_branch L_qpoll
L_qdone:
    v_cvt_pk_bf16_f32 v64, v64, v65
    v_cvt_pk_bf16_f32 v66, v66, v67
    ds_write_b16 v6, v64 offset:0
    ds_write_b16_d16_hi v6, v64 offset:16
    ds_write_b16 v6, v66 offset:32
    ds_write_b16_d16_hi v6, v66 offset:48
    v_mov_b32 v4, 0
    v_mov_b32 v5, 1
    s_waitcnt lgkmcnt(0)
    ds_write_b32 v4, v5 offset:784
    s_setprio 0
    s_mov_b32 s74, 0
    s_mov_b32 s75, 1856
    s_lshl_b32 s80, s73, 10
    s_add_u32 s80, s80, 0xd0000
    s_mov_b32 s82, 1048576
    v_cmp_eq_u32 vcc, 0, v0
    v_mov_b32 v146, 0x80000000
    v_mov_b32 v4, 0
    v_cndmask_b32 v146, v146, 0, vcc
L_go:
    s_sleep 8
    ds_read_b32 v5, v4 offset:768
    s_sub_u32 s82, s82, 1
    s_cbranch_scc1 L_srvend
    s_waitcnt lgkmcnt(0)
    v_readfirstlane_b32 s76, v5
    s_cmp_eq_u32 s76, 0
    s_cbranch_scc1 L_go
L_srv:
    ds_read_b32 v5, v4 offset:512
    s_sub_u32 s82, s82, 1
    s_cbranch_scc1 L_srvend
    s_waitcnt lgkmcnt(0)
    v_readfirstlane_b32 s76, v5
    s_add_u32 s76, s76, 8
    s_cmp_ge_u32 s76, s74
    s_cbranch_scc1 L_fetch
    s_sleep 2
    s_branch L_srv
L_fetch:
    s_mov_b32 s78, 3
    s_sub_u32 s76, s76, s74
    s_add_u32 s78, s78, s76
    s_add_u32 s78, s78, 1
    v_mov_b32 v5, s78
    s_lshl_b32 s77, s74, 2
    buffer_atomic_add v5, v146, s[68:71], s80 offen sc0 sc1
    v_add_u32 v6, s77, v142
    s_waitcnt vmcnt(0)
    v_readfirstlane_b32 s75, v5
    s_add_u32 s76, s75, s78
    s_add_u32 s77, s78, 8
    s_cmp_ge_u32 s76, 2048
    s_cselect_b32 s77, s77, s78
    v_add_u32 v8, s75, v0
    v_cmp_gt_u32 vcc, s77, v0
    v_lshrrev_b32 v7, 11, v8
    v_min_u32 v7, 1, v7
    v_lshlrev_b32 v7, 23, v7
    v_add_u32 v9, 64, v8
    v_lshrrev_b32 v9, 11, v9
    v_min_u32 v9, 1, v9
    v_or_b32 v7, v7, v9
    v_bfe_u32 v9, v8, 0, 1
    v_lshl_or_b32 v7, v9, 15, v7
    v_bfe_u32 v9, v8, 1, 1
    v_lshl_or_b32 v7, v9, 21, v7
    v_bfe_u32 v9, v8, 2, 1
    v_lshl_or_b32 v7, v9, 12, v7
    v_bfe_u32 v9, v8, 3, 1
    v_lshl_or_b32 v7, v9, 13, v7
    v_bfe_u32 v9, v8, 4, 1
    v_lshl_or_b32 v7, v9, 20, v7
    v_bfe_u32 v9, v8, 5, 1
    v_lshl_or_b32 v7, v9, 14, v7
    v_bfe_u32 v9, v8, 6, 1
    v_lshl_or_b32 v7, v9, 16, v7
    v_bfe_u32 v9, v8, 7, 1
    v_lshl_or_b32 v7, v9, 17, v7
    v_bfe_u32 v9, v8, 8, 1
    v_lshl_or_b32 v7, v9, 18, v7
    v_bfe_u32 v9, v8, 9, 1
    v_lshl_or_b32 v7, v9, 19, v7
    v_bfe_u32 v9, v8, 10, 1
    v_lshl_or_b32 v7, v9, 22, v7
    s_mov_b64 exec, vcc
    ds_write_b32 v6, v7 offset:12800
    s_mov_b64 exec, -1
    s_add_u32 s74, s74, s78
    s_mov_b32 s75, s76
    s_cmp_lt_u32 s75, 2048
    s_cbranch_scc1 L_srv
L_srvend:
    s_waitcnt lgkmcnt(0)
    s_endpgm
L_s1:
    v_mul_u32_u24 v1, 36, v0
    v_lshrrev_b32 v2, 4, v0
    s_and_b32 s72, s2, 7
    s_bfe_u32 s73, s2, 0x40003
    s_lshl_b32 s73, s73, 1
    s_lshr_b32 s74, s2, 7
    s_add_u32 s73, s73, s74
    s_waitcnt lgkmcnt(0)
    s_mov_b32 s28, s4
    s_mov_b32 s29, s5
    s_mov_b32 s30, 0x900
    s_mov_b32 s31, 0x20000
    buffer_load_dwordx4 v[12:15], v1, s[28:31], 0 offen
    buffer_load_dwordx4 v[16:19], v1, s[28:31], 0 offen offset:16
    buffer_load_dword v20, v1, s[28:31], 0 offen offset:32
    s_load_dword s84, s[26:27], 0xc0000
    s_barrier
    s_mov_b32 s68, s26
    s_mov_b32 s69, s27
    s_mov_b32 s70, 0x300000
    s_mov_b32 s71, 0x20000
    v_and_b32 v24, 1, v0
    v_cmp_eq_u32 vcc, 1, v24
    v_mov_b32 v24, 0xffff
    v_mov_b32 v25, 0xffff0000
    v_cndmask_b32 v24, v24, v25, vcc
    v_bfe_u32 v25, v0, 1, 2
    v_cmp_eq_u32 vcc, 0, v25
    s_nop 1
    v_cndmask_b32 v8, 0, v24, vcc
    v_cmp_eq_u32 vcc, 1, v25
    s_nop 1
    v_cndmask_b32 v9, 0, v24, vcc
    v_cmp_eq_u32 vcc, 2, v25
    s_nop 1
    v_cndmask_b32 v10, 0, v24, vcc
    v_cmp_eq_u32 vcc, 3, v25
    s_nop 1
    v_cndmask_b32 v11, 0, v24, vcc
    s_waitcnt vmcnt(0)
    v_lshlrev_b32 v28, 16, v12
    v_and_b32 v29, 0xffff0000, v12
    v_lshlrev_b32 v30, 16, v13
    v_and_b32 v31, 0xffff0000, v13
    v_lshlrev_b32 v32, 16, v14
    v_and_b32 v33, 0xffff0000, v14
    v_lshlrev_b32 v34, 16, v15
    v_and_b32 v35, 0xffff0000, v15
    v_lshlrev_b32 v36, 16, v16
    v_and_b32 v37, 0xffff0000, v16
    v_lshlrev_b32 v38, 16, v17
    v_and_b32 v39, 0xffff0000, v17
    v_lshlrev_b32 v40, 16, v18
    v_and_b32 v41, 0xffff0000, v18
    v_lshlrev_b32 v42, 16, v19
    v_and_b32 v43, 0xffff0000, v19
    v_lshlrev_b32 v44, 16, v20
    v_and_b32 v45, 0xffff0000, v20
    v_add_f32 v46, v28, v29
    v_add_f32 v48, v30, v31
    v_add_f32 v46, v46, v32
    v_add_f32 v48, v48, v33
    v_add_f32 v46, v46, v34
    v_add_f32 v48, v48, v35
    v_add_f32 v46, v46, v36
    v_add_f32 v48, v48, v37
    v_add_f32 v46, v46, v38
    v_add_f32 v48, v48, v39
    v_add_f32 v46, v46, v40
    v_add_f32 v48, v48, v41
    v_add_f32 v46, v46, v42
    v_add_f32 v48, v48, v43
    v_add_f32 v46, v46, v44
    v_add_f32 v48, v48, v45
    v_add_f32 v46, v46, v48
    s_nop 1
    v_add_f32_dpp v46, v46, v46 quad_perm:[1,0,3,2] row_mask:0xf bank_mask:0xf
    s_nop 1
    v_add_f32_dpp v46, v46, v46 quad_perm:[2,3,0,1] row_mask:0xf bank_mask:0xf
    s_nop 1
    v_add_f32_dpp v46, v46, v46 row_half_mirror row_mask:0xf bank_mask:0xf
    s_nop 1
    v_add_f32_dpp v46, v46, v46 row_mirror row_mask:0xf bank_mask:0xf
    v_mov_b32 v48, v46
    s_nop 1
    v_permlane16_swap_b32 v46, v48
    s_nop 0
    v_add_f32 v46, v46, v48
    v_mul_f32 v46, 0x3ae38e39, v46
    v_sub_f32 v48, v28, v46
    v_sub_f32 v49, v29, v46
    v_mul_f32 v47, v48, v48
    v_mul_f32 v50, v49, v49
    v_sub_f32 v48, v30, v46
    v_sub_f32 v49, v31, v46
    v_fmac_f32 v47, v48, v48
    v_fmac_f32 v50, v49, v49
    v_sub_f32 v48, v32, v46
    v_sub_f32 v49, v33, v46
    v_fmac_f32 v47, v48, v48
    v_fmac_f32 v50, v49, v49
    v_sub_f32 v48, v34, v46
    v_sub_f32 v49, v35, v46
    v_fmac_f32 v47, v48, v48
    v_fmac_f32 v50, v49, v49
    v_sub_f32 v48, v36, v46
    v_sub_f32 v49, v37, v46
    v_fmac_f32 v47, v48, v48
    v_fmac_f32 v50, v49, v49
    v_sub_f32 v48, v38, v46
    v_sub_f32 v49, v39, v46
    v_fmac_f32 v47, v48, v48
    v_fmac_f32 v50, v49, v49
    v_sub_f32 v48, v40, v46
    v_sub_f32 v49, v41, v46
    v_fmac_f32 v47, v48, v48
    v_fmac_f32 v50, v49, v49
    v_sub_f32 v48, v42, v46
    v_sub_f32 v49, v43, v46
    v_fmac_f32 v47, v48, v48
    v_fmac_f32 v50, v49, v49
    v_sub_f32 v48, v44, v46
    v_sub_f32 v49, v45, v46
    v_fmac_f32 v47, v48, v48
    v_fmac_f32 v50, v49, v49
    v_add_f32 v47, v47, v50
    s_nop 1
    v_add_f32_dpp v47, v47, v47 quad_perm:[1,0,3,2] row_mask:0xf bank_mask:0xf
    s_nop 1
    v_add_f32_dpp v47, v47, v47 quad_perm:[2,3,0,1] row_mask:0xf bank_mask:0xf
    s_nop 1
    v_add_f32_dpp v47, v47, v47 row_half_mirror row_mask:0xf bank_mask:0xf
    s_nop 1
    v_add_f32_dpp v47, v47, v47 row_mirror row_mask:0xf bank_mask:0xf
    v_mov_b32 v48, v47
    s_nop 1
    v_permlane16_swap_b32 v47, v48
    s_nop 0
    v_add_f32 v47, v47, v48
    v_mul_f32 v47, 0x3ae38e39, v47
    v_cvt_pk_bf16_f32 v46, 0, v46
    v_cvt_pk_bf16_f32 v47, 0, v47
    v_add_f32 v47, 0x3727c5ac, v47
    v_cvt_pk_bf16_f32 v47, 0, v47
    v_sqrt_f32 v47, v47
    s_nop 0
    v_cvt_pk_bf16_f32 v47, 0, v47
    v_rcp_f32 v48, v47
    s_nop 0
    v_sub_f32 v28, v28, v46
    v_cvt_pk_bf16_f32 v28, 0, v28
    v_mul_f32 v49, v28, v48
    v_fma_f32 v28, -v49, v47, v28
    v_fma_f32 v28, v28, v48, v49
    v_sub_f32 v29, v29, v46
    v_cvt_pk_bf16_f32 v29, 0, v29
    v_mul_f32 v50, v29, v48
    v_fma_f32 v29, -v50, v47, v29
    v_fma_f32 v29, v29, v48, v50
    v_sub_f32 v30, v30, v46
    v_cvt_pk_bf16_f32 v30, 0, v30
    v_mul_f32 v49, v30, v48
    v_fma_f32 v30, -v49, v47, v30
    v_fma_f32 v30, v30, v48, v49
    v_sub_f32 v31, v31, v46
    v_cvt_pk_bf16_f32 v31, 0, v31
    v_mul_f32 v50, v31, v48
    v_fma_f32 v31, -v50, v47, v31
    v_fma_f32 v31, v31, v48, v50
    v_sub_f32 v32, v32, v46
    v_cvt_pk_bf16_f32 v32, 0, v32
    v_mul_f32 v49, v32, v48
    v_fma_f32 v32, -v49, v47, v32
    v_fma_f32 v32, v32, v48, v49
    v_sub_f32 v33, v33, v46
    v_cvt_pk_bf16_f32 v33, 0, v33
    v_mul_f32 v50, v33, v48
    v_fma_f32 v33, -v50, v47, v33
    v_fma_f32 v33, v33, v48, v50
    v_sub_f32 v34, v34, v46
    v_cvt_pk_bf16_f32 v34, 0, v34
    v_mul_f32 v49, v34, v48
    v_fma_f32 v34, -v49, v47, v34
    v_fma_f32 v34, v34, v48, v49
    v_sub_f32 v35, v35, v46
    v_cvt_pk_bf16_f32 v35, 0, v35
    v_mul_f32 v50, v35, v48
    v_fma_f32 v35, -v50, v47, v35
    v_fma_f32 v35, v35, v48, v50
    v_sub_f32 v36, v36, v46
    v_cvt_pk_bf16_f32 v36, 0, v36
    v_mul_f32 v49, v36, v48
    v_fma_f32 v36, -v49, v47, v36
    v_fma_f32 v36, v36, v48, v49
    v_sub_f32 v37, v37, v46
    v_cvt_pk_bf16_f32 v37, 0, v37
    v_mul_f32 v50, v37, v48
    v_fma_f32 v37, -v50, v47, v37
    v_fma_f32 v37, v37, v48, v50
    v_sub_f32 v38, v38, v46
    v_cvt_pk_bf16_f32 v38, 0, v38
    v_mul_f32 v49, v38, v48
    v_fma_f32 v38, -v49, v47, v38
    v_fma_f32 v38, v38, v48, v49
    v_sub_f32 v39, v39, v46
    v_cvt_pk_bf16_f32 v39, 0, v39
    v_mul_f32 v50, v39, v48
    v_fma_f32 v39, -v50, v47, v39
    v_fma_f32 v39, v39, v48, v50
    v_sub_f32 v40, v40, v46
    v_cvt_pk_bf16_f32 v40, 0, v40
    v_mul_f32 v49, v40, v48
    v_fma_f32 v40, -v49, v47, v40
    v_fma_f32 v40, v40, v48, v49
    v_sub_f32 v41, v41, v46
    v_cvt_pk_bf16_f32 v41, 0, v41
    v_mul_f32 v50, v41, v48
    v_fma_f32 v41, -v50, v47, v41
    v_fma_f32 v41, v41, v48, v50
    v_sub_f32 v42, v42, v46
    v_cvt_pk_bf16_f32 v42, 0, v42
    v_mul_f32 v49, v42, v48
    v_fma_f32 v42, -v49, v47, v42
    v_fma_f32 v42, v42, v48, v49
    v_sub_f32 v43, v43, v46
    v_cvt_pk_bf16_f32 v43, 0, v43
    v_mul_f32 v50, v43, v48
    v_fma_f32 v43, -v50, v47, v43
    v_fma_f32 v43, v43, v48, v50
    v_sub_f32 v44, v44, v46
    v_cvt_pk_bf16_f32 v44, 0, v44
    v_mul_f32 v49, v44, v48
    v_fma_f32 v44, -v49, v47, v44
    v_fma_f32 v44, v44, v48, v49
    v_sub_f32 v45, v45, v46
    v_cvt_pk_bf16_f32 v45, 0, v45
    v_mul_f32 v50, v45, v48
    v_fma_f32 v45, -v50, v47, v45
    v_fma_f32 v45, v45, v48, v50
    v_cvt_pk_bf16_f32 v28, v28, v28
    v_cvt_pk_bf16_f32 v29, v29, v29
    v_cvt_pk_bf16_f32 v30, v30, v30
    v_cvt_pk_bf16_f32 v31, v31, v31
    v_cvt_pk_bf16_f32 v32, v32, v32
    v_cvt_pk_bf16_f32 v33, v33, v33
    v_cvt_pk_bf16_f32 v34, v34, v34
    v_cvt_pk_bf16_f32 v35, v35, v35
    v_cvt_pk_bf16_f32 v36, v36, v36
    v_cvt_pk_bf16_f32 v37, v37, v37
    v_cvt_pk_bf16_f32 v38, v38, v38
    v_cvt_pk_bf16_f32 v39, v39, v39
    v_cvt_pk_bf16_f32 v40, v40, v40
    v_cvt_pk_bf16_f32 v41, v41, v41
    v_cvt_pk_bf16_f32 v42, v42, v42
    v_cvt_pk_bf16_f32 v43, v43, v43
    v_cvt_pk_bf16_f32 v44, v44, v44
    v_cvt_pk_bf16_f32 v45, v45, v45
    v_lshlrev_b32 v1, 1, v1
    ds_write_b64 v1, v[28:29] offset:7168
    ds_write_b64 v1, v[30:31] offset:7176
    ds_write_b64 v1, v[32:33] offset:7184
    ds_write_b64 v1, v[34:35] offset:7192
    ds_write_b64 v1, v[36:37] offset:7200
    ds_write_b64 v1, v[38:39] offset:7208
    ds_write_b64 v1, v[40:41] offset:7216
    ds_write_b64 v1, v[42:43] offset:7224
    ds_write_b64 v1, v[44:45] offset:7232
    v_mov_b32 v4, 0
    s_mov_b32 s82, 262144
L_dw:
    s_sleep 8
    ds_read_b32 v5, v4 offset:780
    s_sub_u32 s82, s82, 1
    s_cbranch_scc1 L_dw2
    s_waitcnt lgkmcnt(0)
    v_readfirstlane_b32 s76, v5
    s_cmp_lt_u32 s76, 4
    s_cbranch_scc1 L_dw
L_dw2:
    s_waitcnt lgkmcnt(0)
    s_add_u32 s81, s84, 1
    s_and_b32 s84, s81, 0xff
    s_mov_b32 s85, 0xffffff00
    v_mov_b32 v6, s84
    s_lshl_b32 s86, s72, 5
    s_lshr_b32 s87, s2, 3
    s_add_u32 s86, s86, s87
    s_cmp_ge_u32 s86, 216
    s_cbranch_scc1 L_nogu
    s_mul_i32 s75, s86, 0x5556
    s_lshr_b32 s75, s75, 16
    s_mul_i32 s76, s75, 3
    s_sub_u32 s76, s86, s76
    s_cmp_ge_u32 s75, 36
    s_cselect_b32 s77, 36, 0
    s_cselect_b32 s78, 3, 0
    s_sub_u32 s75, s75, s77
    s_add_u32 s78, s78, s76
    v_bfe_u32 v14, v0, 3, 1
    v_mul_u32_u24 v13, 2304, v14
    v_mul_u32_u24 v15, 192, v2
    s_mul_i32 s77, s76, 768
    v_add3_u32 v13, v13, v15, s77
    ds_read_b128 v[60:63], v13 offset:7168
    ds_read_b128 v[64:67], v13 offset:7184
    ds_read_b128 v[68:71], v13 offset:7200
    ds_read_b128 v[72:75], v13 offset:7216
    ds_read_b128 v[76:79], v13 offset:7232
    ds_read_b128 v[80:83], v13 offset:7248
    ds_read_b128 v[84:87], v13 offset:7264
    ds_read_b128 v[88:91], v13 offset:7280
    ds_read_b128 v[92:95], v13 offset:7296
    ds_read_b128 v[96:99], v13 offset:7312
    ds_read_b128 v[100:103], v13 offset:7328
    ds_read_b128 v[104:107], v13 offset:7344
    v_lshlrev_b32 v12, 4, v0
    v_add_u32 v12, 33792, v12
    v_mul_u32_u24 v14, 18432, v14
    v_lshl_add_u32 v14, v2, 7, v14
    v_and_b32 v15, 7, v0
    v_lshl_add_u32 v14, v15, 4, v14
    s_mul_i32 s78, s78, 36864
    s_lshl_b32 s75, s75, 9
    s_add_u32 s78, s78, s75
    s_add_u32 s78, s78, 0x240000
    s_waitcnt lgkmcnt(0)
    ds_read_b128 v[112:115], v12 offset:0
    ds_read_b128 v[116:119], v12 offset:1024
    ds_read_b128 v[120:123], v12 offset:2048
    ds_read_b128 v[124:127], v12 offset:3072
    ds_read_b128 v[128:131], v12 offset:4096
    ds_read_b128 v[132:135], v12 offset:5120
    ds_read_b128 v[136:139], v12 offset:6144
    ds_read_b128 v[140:143], v12 offset:7168
    v_and_b32 v24, v60, v8
    v_and_b32 v25, v60, v9
    v_and_b32 v26, v60, v10
    v_and_b32 v27, v60, v11
    s_waitcnt lgkmcnt(7)
    ds_read_b128 v[144:147], v12 offset:8192
    v_mfma_f32_16x16x32_bf16 v[16:19], v[112:115], v[24:27], 0
    v_and_b32 v28, v61, v8
    v_and_b32 v29, v61, v9
    v_and_b32 v30, v61, v10
    v_and_b32 v31, v61, v11
    s_waitcnt lgkmcnt(7)
    ds_read_b128 v[148:151], v12 offset:9216
    v_mfma_f32_16x16x32_bf16 v[16:19], v[116:119], v[28:31], v[16:19]
    v_and_b32 v24, v62, v8
    v_and_b32 v25, v62, v9
    v_and_b32 v26, v62, v10
    v_and_b32 v27, v62, v11
    s_waitcnt lgkmcnt(7)
    ds_read_b128 v[152:155], v12 offset:10240
    v_mfma_f32_16x16x32_bf16 v[16:19], v[120:123], v[24:27], v[16:19]
    v_and_b32 v28, v63, v8
    v_and_b32 v29, v63, v9
    v_and_b32 v30, v63, v10
    v_and_b32 v31, v63, v11
    s_waitcnt lgkmcnt(7)
    ds_read_b128 v[156:159], v12 offset:11264
    v_mfma_f32_16x16x32_bf16 v[16:19], v[124:127], v[28:31], v[16:19]
    v_and_b32 v24, v64, v8
    v_and_b32 v25, v64, v9
    v_and_b32 v26, v64, v10
    v_and_b32 v27, v64, v11
    s_waitcnt lgkmcnt(7)
    ds_read_b128 v[112:115], v12 offset:12288
    v_mfma_f32_16x16x32_bf16 v[16:19], v[128:131], v[24:27], v[16:19]
    v_and_b32 v28, v65, v8
    v_and_b32 v29, v65, v9
    v_and_b32 v30, v65, v10
    v_and_b32 v31, v65, v11
    s_waitcnt lgkmcnt(7)
    ds_read_b128 v[116:119], v12 offset:13312
    v_mfma_f32_16x16x32_bf16 v[16:19], v[132:135], v[28:31], v[16:19]
    v_and_b32 v24, v66, v8
    v_and_b32 v25, v66, v9
    v_and_b32 v26, v66, v10
    v_and_b32 v27, v66, v11
    s_waitcnt lgkmcnt(7)
    ds_read_b128 v[120:123], v12 offset:14336
    v_mfma_f32_16x16x32_bf16 v[16:19], v[136:139], v[24:27], v[16:19]
    v_and_b32 v28, v67, v8
    v_and_b32 v29, v67, v9
    v_and_b32 v30, v67, v10
    v_and_b32 v31, v67, v11
    s_waitcnt lgkmcnt(7)
    ds_read_b128 v[124:127], v12 offset:15360
    v_mfma_f32_16x16x32_bf16 v[16:19], v[140:143], v[28:31], v[16:19]
    v_and_b32 v24, v68, v8
    v_and_b32 v25, v68, v9
    v_and_b32 v26, v68, v10
    v_and_b32 v27, v68, v11
    s_waitcnt lgkmcnt(7)
    ds_read_b128 v[128:131], v12 offset:16384
    v_mfma_f32_16x16x32_bf16 v[16:19], v[144:147], v[24:27], v[16:19]
    v_and_b32 v28, v69, v8
    v_and_b32 v29, v69, v9
    v_and_b32 v30, v69, v10
    v_and_b32 v31, v69, v11
    s_waitcnt lgkmcnt(7)
    ds_read_b128 v[132:135], v12 offset:17408
    v_mfma_f32_16x16x32_bf16 v[16:19], v[148:151], v[28:31], v[16:19]
    v_and_b32 v24, v70, v8
    v_and_b32 v25, v70, v9
    v_and_b32 v26, v70, v10
    v_and_b32 v27, v70, v11
    s_waitcnt lgkmcnt(7)
    ds_read_b128 v[136:139], v12 offset:18432
    v_mfma_f32_16x16x32_bf16 v[16:19], v[152:155], v[24:27], v[16:19]
    v_and_b32 v28, v71, v8
    v_and_b32 v29, v71, v9
    v_and_b32 v30, v71, v10
    v_and_b32 v31, v71, v11
    s_waitcnt lgkmcnt(7)
    ds_read_b128 v[140:143], v12 offset:19456
    v_mfma_f32_16x16x32_bf16 v[16:19], v[156:159], v[28:31], v[16:19]
    v_and_b32 v24, v72, v8
    v_and_b32 v25, v72, v9
    v_and_b32 v26, v72, v10
    v_and_b32 v27, v72, v11
    s_waitcnt lgkmcnt(7)
    ds_read_b128 v[144:147], v12 offset:20480
    v_mfma_f32_16x16x32_bf16 v[16:19], v[112:115], v[24:27], v[16:19]
    v_and_b32 v28, v73, v8
    v_and_b32 v29, v73, v9
    v_and_b32 v30, v73, v10
    v_and_b32 v31, v73, v11
    s_waitcnt lgkmcnt(7)
    ds_read_b128 v[148:151], v12 offset:21504
    v_mfma_f32_16x16x32_bf16 v[16:19], v[116:119], v[28:31], v[16:19]
    v_and_b32 v24, v74, v8
    v_and_b32 v25, v74, v9
    v_and_b32 v26, v74, v10
    v_and_b32 v27, v74, v11
    s_waitcnt lgkmcnt(7)
    ds_read_b128 v[152:155], v12 offset:22528
    v_mfma_f32_16x16x32_bf16 v[16:19], v[120:123], v[24:27], v[16:19]
    v_and_b32 v28, v75, v8
    v_and_b32 v29, v75, v9
    v_and_b32 v30, v75, v10
    v_and_b32 v31, v75, v11
    s_waitcnt lgkmcnt(7)
    ds_read_b128 v[156:159], v12 offset:23552
    v_mfma_f32_16x16x32_bf16 v[16:19], v[124:127], v[28:31], v[16:19]
    v_and_b32 v24, v76, v8
    v_and_b32 v25, v76, v9
    v_and_b32 v26, v76, v10
    v_and_b32 v27, v76, v11
    s_waitcnt lgkmcnt(7)
    ds_read_b128 v[112:115], v12 offset:24576
    v_mfma_f32_16x16x32_bf16 v[16:19], v[128:131], v[24:27], v[16:19]
    v_and_b32 v28, v77, v8
    v_and_b32 v29, v77, v9
    v_and_b32 v30, v77, v10
    v_and_b32 v31, v77, v11
    s_waitcnt lgkmcnt(7)
    ds_read_b128 v[116:119], v12 offset:25600
    v_mfma_f32_16x16x32_bf16 v[16:19], v[132:135], v[28:31], v[16:19]
    v_and_b32 v24, v78, v8
    v_and_b32 v25, v78, v9
    v_and_b32 v26, v78, v10
    v_and_b32 v27, v78, v11
    s_waitcnt lgkmcnt(7)
    ds_read_b128 v[120:123], v12 offset:26624
    v_mfma_f32_16x16x32_bf16 v[16:19], v[136:139], v[24:27], v[16:19]
    v_and_b32 v28, v79, v8
    v_and_b32 v29, v79, v9
    v_and_b32 v30, v79, v10
    v_and_b32 v31, v79, v11
    s_waitcnt lgkmcnt(7)
    ds_read_b128 v[124:127], v12 offset:27648
    v_mfma_f32_16x16x32_bf16 v[16:19], v[140:143], v[28:31], v[16:19]
    v_and_b32 v24, v80, v8
    v_and_b32 v25, v80, v9
    v_and_b32 v26, v80, v10
    v_and_b32 v27, v80, v11
    s_waitcnt lgkmcnt(7)
    ds_read_b128 v[128:131], v12 offset:28672
    v_mfma_f32_16x16x32_bf16 v[16:19], v[144:147], v[24:27], v[16:19]
    v_and_b32 v28, v81, v8
    v_and_b32 v29, v81, v9
    v_and_b32 v30, v81, v10
    v_and_b32 v31, v81, v11
    s_waitcnt lgkmcnt(7)
    ds_read_b128 v[132:135], v12 offset:29696
    v_mfma_f32_16x16x32_bf16 v[16:19], v[148:151], v[28:31], v[16:19]
    v_and_b32 v24, v82, v8
    v_and_b32 v25, v82, v9
    v_and_b32 v26, v82, v10
    v_and_b32 v27, v82, v11
    s_waitcnt lgkmcnt(7)
    ds_read_b128 v[136:139], v12 offset:30720
    v_mfma_f32_16x16x32_bf16 v[16:19], v[152:155], v[24:27], v[16:19]
    v_and_b32 v28, v83, v8
    v_and_b32 v29, v83, v9
    v_and_b32 v30, v83, v10
    v_and_b32 v31, v83, v11
    s_waitcnt lgkmcnt(7)
    ds_read_b128 v[140:143], v12 offset:31744
    v_mfma_f32_16x16x32_bf16 v[16:19], v[156:159], v[28:31], v[16:19]
    v_and_b32 v24, v84, v8
    v_and_b32 v25, v84, v9
    v_and_b32 v26, v84, v10
    v_and_b32 v27, v84, v11
    s_waitcnt lgkmcnt(7)
    ds_read_b128 v[144:147], v12 offset:32768
    v_mfma_f32_16x16x32_bf16 v[16:19], v[112:115], v[24:27], v[16:19]
    v_and_b32 v28, v85, v8
    v_and_b32 v29, v85, v9
    v_and_b32 v30, v85, v10
    v_and_b32 v31, v85, v11
    s_waitcnt lgkmcnt(7)
    ds_read_b128 v[148:151], v12 offset:33792
    v_mfma_f32_16x16x32_bf16 v[16:19], v[116:119], v[28:31], v[16:19]
    v_and_b32 v24, v86, v8
    v_and_b32 v25, v86, v9
    v_and_b32 v26, v86, v10
    v_and_b32 v27, v86, v11
    s_waitcnt lgkmcnt(7)
    ds_read_b128 v[152:155], v12 offset:34816
    v_mfma_f32_16x16x32_bf16 v[16:19], v[120:123], v[24:27], v[16:19]
    v_and_b32 v28, v87, v8
    v_and_b32 v29, v87, v9
    v_and_b32 v30, v87, v10
    v_and_b32 v31, v87, v11
    s_waitcnt lgkmcnt(7)
    ds_read_b128 v[156:159], v12 offset:35840
    v_mfma_f32_16x16x32_bf16 v[16:19], v[124:127], v[28:31], v[16:19]
    v_and_b32 v24, v88, v8
    v_and_b32 v25, v88, v9
    v_and_b32 v26, v88, v10
    v_and_b32 v27, v88, v11
    s_waitcnt lgkmcnt(7)
    ds_read_b128 v[112:115], v12 offset:36864
    v_mfma_f32_16x16x32_bf16 v[16:19], v[128:131], v[24:27], v[16:19]
    v_and_b32 v28, v89, v8
    v_and_b32 v29, v89, v9
    v_and_b32 v30, v89, v10
    v_and_b32 v31, v89, v11
    s_waitcnt lgkmcnt(7)
    ds_read_b128 v[116:119], v12 offset:37888
    v_mfma_f32_16x16x32_bf16 v[16:19], v[132:135], v[28:31], v[16:19]
    v_and_b32 v24, v90, v8
    v_and_b32 v25, v90, v9
    v_and_b32 v26, v90, v10
    v_and_b32 v27, v90, v11
    s_waitcnt lgkmcnt(7)
    ds_read_b128 v[120:123], v12 offset:38912
    v_mfma_f32_16x16x32_bf16 v[16:19], v[136:139], v[24:27], v[16:19]
    v_and_b32 v28, v91, v8
    v_and_b32 v29, v91, v9
    v_and_b32 v30, v91, v10
    v_and_b32 v31, v91, v11
    s_waitcnt lgkmcnt(7)
    ds_read_b128 v[124:127], v12 offset:39936
    v_mfma_f32_16x16x32_bf16 v[16:19], v[140:143], v[28:31], v[16:19]
    v_and_b32 v24, v92, v8
    v_and_b32 v25, v92, v9
    v_and_b32 v26, v92, v10
    v_and_b32 v27, v92, v11
    s_waitcnt lgkmcnt(7)
    ds_read_b128 v[128:131], v12 offset:40960
    v_mfma_f32_16x16x32_bf16 v[16:19], v[144:147], v[24:27], v[16:19]
    v_and_b32 v28, v93, v8
    v_and_b32 v29, v93, v9
    v_and_b32 v30, v93, v10
    v_and_b32 v31, v93, v11
    s_waitcnt lgkmcnt(7)
    ds_read_b128 v[132:135], v12 offset:41984
    v_mfma_f32_16x16x32_bf16 v[16:19], v[148:151], v[28:31], v[16:19]
    v_and_b32 v24, v94, v8
    v_and_b32 v25, v94, v9
    v_and_b32 v26, v94, v10
    v_and_b32 v27, v94, v11
    s_waitcnt lgkmcnt(7)
    ds_read_b128 v[136:139], v12 offset:43008
    v_mfma_f32_16x16x32_bf16 v[16:19], v[152:155], v[24:27], v[16:19]
    v_and_b32 v28, v95, v8
    v_and_b32 v29, v95, v9
    v_and_b32 v30, v95, v10
    v_and_b32 v31, v95, v11
    s_waitcnt lgkmcnt(7)
    ds_read_b128 v[140:143], v12 offset:44032
    v_mfma_f32_16x16x32_bf16 v[16:19], v[156:159], v[28:31], v[16:19]
    v_and_b32 v24, v96, v8
    v_and_b32 v25, v96, v9
    v_and_b32 v26, v96, v10
    v_and_b32 v27, v96, v11
    s_waitcnt lgkmcnt(7)
    ds_read_b128 v[144:147], v12 offset:45056
    v_mfma_f32_16x16x32_bf16 v[16:19], v[112:115], v[24:27], v[16:19]
    v_and_b32 v28, v97, v8
    v_and_b32 v29, v97, v9
    v_and_b32 v30, v97, v10
    v_and_b32 v31, v97, v11
    s_waitcnt lgkmcnt(7)
    ds_read_b128 v[148:151], v12 offset:46080
    v_mfma_f32_16x16x32_bf16 v[16:19], v[116:119], v[28:31], v[16:19]
    v_and_b32 v24, v98, v8
    v_and_b32 v25, v98, v9
    v_and_b32 v26, v98, v10
    v_and_b32 v27, v98, v11
    s_waitcnt lgkmcnt(7)
    ds_read_b128 v[152:155], v12 offset:47104
    v_mfma_f32_16x16x32_bf16 v[16:19], v[120:123], v[24:27], v[16:19]
    v_and_b32 v28, v99, v8
    v_and_b32 v29, v99, v9
    v_and_b32 v30, v99, v10
    v_and_b32 v31, v99, v11
    s_waitcnt lgkmcnt(7)
    ds_read_b128 v[156:159], v12 offset:48128
    v_mfma_f32_16x16x32_bf16 v[16:19], v[124:127], v[28:31], v[16:19]
    v_and_b32 v24, v100, v8
    v_and_b32 v25, v100, v9
    v_and_b32 v26, v100, v10
    v_and_b32 v27, v100, v11
    s_waitcnt lgkmcnt(7)
    s_nop 0
    v_mfma_f32_16x16x32_bf16 v[16:19], v[128:131], v[24:27], v[16:19]
    v_and_b32 v28, v101, v8
    v_and_b32 v29, v101, v9
    v_and_b32 v30, v101, v10
    v_and_b32 v31, v101, v11
    s_waitcnt lgkmcnt(6)
    s_nop 0
    v_mfma_f32_16x16x32_bf16 v[16:19], v[132:135], v[28:31], v[16:19]
    v_and_b32 v24, v102, v8
    v_and_b32 v25, v102, v9
    v_and_b32 v26, v102, v10
    v_and_b32 v27, v102, v11
    s_waitcnt lgkmcnt(5)
    s_nop 0
    v_mfma_f32_16x16x32_bf16 v[16:19], v[136:139], v[24:27], v[16:19]
    v_and_b32 v28, v103, v8
    v_and_b32 v29, v103, v9
    v_and_b32 v30, v103, v10
    v_and_b32 v31, v103, v11
    s_waitcnt lgkmcnt(4)
    s_nop 0
    v_mfma_f32_16x16x32_bf16 v[16:19], v[140:143], v[28:31], v[16:19]
    v_and_b32 v24, v104, v8
    v_and_b32 v25, v104, v9
    v_and_b32 v26, v104, v10
    v_and_b32 v27, v104, v11
    s_waitcnt lgkmcnt(3)
    s_nop 0
    v_mfma_f32_16x16x32_bf16 v[16:19], v[144:147], v[24:27], v[16:19]
    v_and_b32 v28, v105, v8
    v_and_b32 v29, v105, v9
    v_and_b32 v30, v105, v10
    v_and_b32 v31, v105, v11
    s_waitcnt lgkmcnt(2)
    s_nop 0
    v_mfma_f32_16x16x32_bf16 v[16:19], v[148:151], v[28:31], v[16:19]
    v_and_b32 v24, v106, v8
    v_and_b32 v25, v106, v9
    v_and_b32 v26, v106, v10
    v_and_b32 v27, v106, v11
    s_waitcnt lgkmcnt(1)
    s_nop 0
    v_mfma_f32_16x16x32_bf16 v[16:19], v[152:155], v[24:27], v[16:19]
    v_and_b32 v28, v107, v8
    v_and_b32 v29, v107, v9
    v_and_b32 v30, v107, v10
    v_and_b32 v31, v107, v11
    s_waitcnt lgkmcnt(0)
    s_nop 0
    v_mfma_f32_16x16x32_bf16 v[16:19], v[156:159], v[28:31], v[16:19]
    s_nop 7
    v_add_u32 v16, 0x80, v16
    v_add_u32 v17, 0x80, v17
    v_add_u32 v18, 0x80, v18
    v_add_u32 v19, 0x80, v19
    v_and_or_b32 v16, v16, s85, v6
    v_and_or_b32 v17, v17, s85, v6
    v_and_or_b32 v18, v18, s85, v6
    v_and_or_b32 v19, v19, s85, v6
    buffer_store_dwordx4 v[16:19], v14, s[68:71], s78 offen sc1
L_nogu:
    v_lshrrev_b32 v20, 1, v0
    v_subrev_u32 v22, 32, v20
    v_cmp_lt_u32 vcc, 24, v20
    s_mul_i32 s75, s2, 18
    v_and_b32 v21, 1, v0
    v_cndmask_b32 v20, v20, v22, vcc
    v_add_u32 v20, s75, v20
    v_max_i32 v20, 0, v20
    v_min_i32 v20, 4607, v20
    v_mul_u32_u24 v21, 18432, v21
    v_lshl_add_u32 v21, v20, 2, v21
    v_add_u32 v21, 0x240000, v21
    v_lshlrev_b32 v3, 2, v0
    s_mov_b32 s82, 262144
L_gpoll:
    s_mov_b32 s75, 0
    buffer_load_dword v24, v21, s[68:71], s75 offen sc1
    s_add_u32 s75, s75, 36864
    buffer_load_dword v25, v21, s[68:71], s75 offen sc1
    s_add_u32 s75, s75, 36864
    buffer_load_dword v26, v21, s[68:71], s75 offen sc1
    s_add_u32 s75, s75, 36864
    buffer_load_dword v27, v21, s[68:71], s75 offen sc1
    s_add_u32 s75, s75, 36864
    buffer_load_dword v28, v21, s[68:71], s75 offen sc1
    s_add_u32 s75, s75, 36864
    buffer_load_dword v29, v21, s[68:71], s75 offen sc1
    s_add_u32 s75, s75, 36864
    s_waitcnt vmcnt(0)
    v_xor_b32 v24, v6, v24
    v_xor_b32 v25, v6, v25
    v_xor_b32 v26, v6, v26
    v_xor_b32 v27, v6, v27
    v_xor_b32 v28, v6, v28
    v_xor_b32 v29, v6, v29
    v_or3_b32 v22, v24, v25, v26
    v_or3_b32 v23, v27, v28, v29
    v_or_b32 v22, v22, v23
    v_and_b32 v22, 0xff, v22
    v_cmp_ne_u32 vcc, 0, v22
    s_sub_u32 s82, s82, 1
    s_cbranch_scc1 L_gdone
    s_cbranch_vccz L_gdone
    s_sleep 32
    s_branch L_gpoll
L_gdone:
    v_add_f32 v16, v24, v25
    v_add_f32 v34, v27, v28
    v_add_f32 v16, v16, v26
    v_add_f32 v34, v34, v29
    v_cvt_pk_bf16_f32 v16, 0, v16
    v_cvt_pk_bf16_f32 v34, 0, v34
    v_mul_f32 v17, 0xbfb8aa3b, v16
    v_exp_f32 v17, v17
    s_nop 0
    v_add_f32 v17, 1.0, v17
    v_rcp_f32 v17, v17
    s_nop 0
    v_mul_f32 v16, v16, v17
    v_cvt_pk_bf16_f32 v16, 0, v16
    v_mul_f32 v16, v16, v34
    v_cvt_pk_bf16_f32 v16, v16, v16
    v_cmp_gt_u32 vcc, 36, v0
    s_nop 1
    v_cndmask_b32 v16, 0, v16, vcc
    ds_write_b32 v3, v16 offset:12288
    v_lshrrev_b32 v2, 3, v0
    v_lshlrev_b32 v2, 2, v2
    s_waitcnt lgkmcnt(0)
    ds_read_b32 v34, v2 offset:12288
    ds_read_b32 v35, v2 offset:12320
    ds_read_b32 v36, v2 offset:12352
    ds_read_b32 v37, v2 offset:12384
    ds_read_b32 v38, v2 offset:12416
    v_bfe_u32 v1, v0, 3, 1
    v_mul_u32_u24 v14, 36, v1
    v_lshrrev_b32 v1, 4, v0
    v_lshl_add_u32 v14, v1, 1, v14
    v_bfe_u32 v1, v0, 2, 1
    v_add_u32 v14, v14, v1
    v_lshlrev_b32 v14, 14, v14
    v_and_b32 v1, 3, v0
    v_lshl_add_u32 v14, v1, 4, v14
    v_cmp_gt_u32 vcc, 32, v0
    v_mov_b32 v1, 0x80000000
    s_lshl_b32 s83, s73, 3
    s_add_u32 s83, s83, s72
    s_lshl_b32 s83, s83, 6
    s_add_u32 s83, s83, 0x100000
    v_cndmask_b32 v15, v1, v14, vcc
    v_bfe_u32 v1, v0, 3, 1
    v_lshlrev_b32 v12, 17, v1
    v_lshlrev_b32 v13, 11, v1
    v_and_b32 v1, 7, v0
    v_lshl_add_u32 v12, v1, 9, v12
    v_lshl_add_u32 v13, v1, 4, v13
    v_lshrrev_b32 v1, 4, v0
    v_lshl_add_u32 v12, v1, 4, v12
    s_waitcnt lgkmcnt(0)
    s_mov_b32 s56, s20
    s_mov_b32 s57, s21
    s_mov_b32 s58, 0x510000
    s_mov_b32 s59, 0x20000
    s_mov_b32 s44, s12
    s_mov_b32 s45, s13
    s_mov_b32 s46, 0x480000
    s_mov_b32 s47, 0x20000
    v_and_b32 v3, 15, v0
    v_mov_b32 v7, 0x80000000
    v_cmp_gt_u32 s[42:43], 8, v3
    s_mul_i32 s75, s2, 18
    v_and_b32 v2, 1, v1
    v_add_u32 v20, s75, v1
    v_and_b32 v21, 0xffffffe0, v20
    v_and_b32 v22, 3, v20
    v_lshl_add_u32 v21, v22, 3, v21
    v_bfe_u32 v22, v20, 2, 3
    v_add_u32 v21, v21, v22
    v_mul_u32_u24 v21, 1152, v21
    v_lshl_add_u32 v40, v3, 4, v21
    s_add_u32 s75, s75, 4
    v_cndmask_b32 v41, v7, v40, s[42:43]
    v_add_u32 v20, s75, v1
    v_and_b32 v21, 0xffffffe0, v20
    v_and_b32 v22, 3, v20
    v_lshl_add_u32 v21, v22, 3, v21
    v_bfe_u32 v22, v20, 2, 3
    v_add_u32 v21, v21, v22
    v_mul_u32_u24 v21, 1152, v21
    v_lshl_add_u32 v42, v3, 4, v21
    s_add_u32 s75, s75, 4
    v_cndmask_b32 v43, v7, v42, s[42:43]
    v_add_u32 v20, s75, v1
    v_and_b32 v21, 0xffffffe0, v20
    v_and_b32 v22, 3, v20
    v_lshl_add_u32 v21, v22, 3, v21
    v_bfe_u32 v22, v20, 2, 3
    v_add_u32 v21, v21, v22
    v_mul_u32_u24 v21, 1152, v21
    v_lshl_add_u32 v44, v3, 4, v21
    s_add_u32 s75, s75, 4
    v_cndmask_b32 v45, v7, v44, s[42:43]
    v_add_u32 v20, s75, v1
    v_and_b32 v21, 0xffffffe0, v20
    v_and_b32 v22, 3, v20
    v_lshl_add_u32 v21, v22, 3, v21
    v_bfe_u32 v22, v20, 2, 3
    v_add_u32 v21, v21, v22
    v_mul_u32_u24 v21, 1152, v21
    v_lshl_add_u32 v46, v3, 4, v21
    s_add_u32 s75, s75, 4
    v_cndmask_b32 v47, v7, v46, s[42:43]
    v_add_u32 v20, s75, v2
    v_and_b32 v21, 0xffffffe0, v20
    v_and_b32 v22, 3, v20
    v_lshl_add_u32 v21, v22, 3, v21
    v_bfe_u32 v22, v20, 2, 3
    v_add_u32 v21, v21, v22
    v_mul_u32_u24 v21, 1152, v21
    v_lshl_add_u32 v48, v3, 4, v21
    s_add_u32 s75, s75, 4
    v_cndmask_b32 v49, v7, v48, s[42:43]
    v_mul_u32_u24 v50, 1152, v1
    v_lshl_add_u32 v50, v3, 4, v50
    v_mov_b32 v4, 0
    v_cndmask_b32 v51, v7, v50, s[42:43]
    s_lshl_b32 s74, s73, 7
    s_lshr_b32 s75, s72, 1
    s_lshl_b32 s75, s75, 5
    s_add_u32 s74, s74, s75
    s_and_b32 s75, s72, 1
    s_lshl_b32 s75, s75, 2
    s_add_u32 s74, s74, s75
    s_mul_i32 s74, s74, 1152
    s_mov_b32 s82, 1048576
    s_barrier
L_fin2:
    buffer_load_dwordx4 v[60:63], v40, s[56:59], 0 offen offset:0 nt
    buffer_load_dwordx4 v[64:67], v40, s[56:59], 0 offen offset:256 nt
    buffer_load_dwordx4 v[68:71], v40, s[56:59], 0 offen offset:512 nt
    buffer_load_dwordx4 v[72:75], v40, s[56:59], 0 offen offset:768 nt
    buffer_load_dwordx4 v[76:79], v41, s[56:59], 0 offen offset:1024 nt
    buffer_load_dwordx4 v[80:83], v42, s[56:59], 0 offen offset:0 nt
    buffer_load_dwordx4 v[84:87], v42, s[56:59], 0 offen offset:256 nt
    buffer_load_dwordx4 v[88:91], v42, s[56:59], 0 offen offset:512 nt
    buffer_load_dwordx4 v[92:95], v42, s[56:59], 0 offen offset:768 nt
    buffer_load_dwordx4 v[96:99], v43, s[56:59], 0 offen offset:1024 nt
    buffer_load_dwordx4 v[100:103], v44, s[56:59], 0 offen offset:0 nt
    buffer_load_dwordx4 v[104:107], v44, s[56:59], 0 offen offset:256 nt
    buffer_load_dwordx4 v[108:111], v44, s[56:59], 0 offen offset:512 nt
    buffer_load_dwordx4 v[112:115], v44, s[56:59], 0 offen offset:768 nt
    buffer_load_dwordx4 v[116:119], v45, s[56:59], 0 offen offset:1024 nt
    buffer_load_dwordx4 v[120:123], v46, s[56:59], 0 offen offset:0 nt
    buffer_load_dwordx4 v[124:127], v46, s[56:59], 0 offen offset:256 nt
    buffer_load_dwordx4 v[128:131], v46, s[56:59], 0 offen offset:512 nt
    buffer_load_dwordx4 v[132:135], v46, s[56:59], 0 offen offset:768 nt
    buffer_load_dwordx4 v[136:139], v47, s[56:59], 0 offen offset:1024 nt
    buffer_load_dwordx4 v[140:143], v48, s[56:59], 0 offen offset:0 nt
    buffer_load_dwordx4 v[144:147], v48, s[56:59], 0 offen offset:256 nt
    buffer_load_dwordx4 v[148:151], v48, s[56:59], 0 offen offset:512 nt
    buffer_load_dwordx4 v[152:155], v48, s[56:59], 0 offen offset:768 nt
    buffer_load_dwordx4 v[156:159], v49, s[56:59], 0 offen offset:1024 nt
    buffer_load_dwordx4 v[160:163], v50, s[44:47], s74 offen offset:0 nt
    buffer_load_dwordx4 v[164:167], v50, s[44:47], s74 offen offset:256 nt
    buffer_load_dwordx4 v[168:171], v50, s[44:47], s74 offen offset:512 nt
    buffer_load_dwordx4 v[172:175], v50, s[44:47], s74 offen offset:768 nt
    buffer_load_dwordx4 v[176:179], v51, s[44:47], s74 offen offset:1024 nt
    s_add_u32 s74, s74, 9216
    buffer_load_dwordx4 v[180:183], v50, s[44:47], s74 offen offset:0 nt
    buffer_load_dwordx4 v[184:187], v50, s[44:47], s74 offen offset:256 nt
    buffer_load_dwordx4 v[188:191], v50, s[44:47], s74 offen offset:512 nt
    buffer_load_dwordx4 v[192:195], v50, s[44:47], s74 offen offset:768 nt
    buffer_load_dwordx4 v[196:199], v51, s[44:47], s74 offen offset:1024 nt
    s_add_u32 s74, s74, 9216
    buffer_load_dwordx4 v[200:203], v50, s[44:47], s74 offen offset:0 nt
    buffer_load_dwordx4 v[204:207], v50, s[44:47], s74 offen offset:256 nt
    buffer_load_dwordx4 v[208:211], v50, s[44:47], s74 offen offset:512 nt
    buffer_load_dwordx4 v[212:215], v50, s[44:47], s74 offen offset:768 nt
    buffer_load_dwordx4 v[216:219], v51, s[44:47], s74 offen offset:1024 nt
    s_add_u32 s74, s74, 9216
    buffer_load_dwordx4 v[220:223], v50, s[44:47], s74 offen offset:0 nt
    buffer_load_dwordx4 v[224:227], v50, s[44:47], s74 offen offset:256 nt
    buffer_load_dwordx4 v[228:231], v50, s[44:47], s74 offen offset:512 nt
    buffer_load_dwordx4 v[232:235], v50, s[44:47], s74 offen offset:768 nt
    buffer_load_dwordx4 v[236:239], v51, s[44:47], s74 offen offset:1024 nt
    s_lshl_b32 s74, s73, 12
    s_lshl_b32 s75, s72, 6
    s_add_u32 s74, s74, s75
    s_add_u32 s74, s74, 0x40000
    s_lshr_b32 s75, s73, 1
    s_lshl_b32 s75, s75, 7
    s_and_b32 s76, s73, 1
    s_lshl_b32 s76, s76, 12
    s_add_u32 s75, s75, s76
    s_add_u32 s75, s75, 0x80000
    s_mov_b32 s76, 0x3fb8aa3b
    s_mov_b32 s82, 262144
    s_mov_b64 s[40:41], -1
    s_waitcnt lgkmcnt(0)
    s_mov_b64 exec, s[40:41]
    buffer_load_dwordx4 v[244:247], v13, s[68:71], s75 offen sc1
    buffer_load_dwordx4 v[240:243], v12, s[68:71], s74 offen sc1
    s_waitcnt vmcnt(22)
    s_mov_b64 exec, s[40:41]
    buffer_load_dwordx4 v[252:255], v13, s[68:71], s75 offen sc1
    buffer_load_dwordx4 v[248:251], v12, s[68:71], s74 offen sc1
    v_and_b32 v24, v34, v8
    v_and_b32 v25, v34, v9
    v_and_b32 v26, v34, v10
    v_and_b32 v27, v34, v11
    s_nop 1
    v_mfma_f32_16x16x32_bf16 v[40:43], v[60:63], v[24:27], 0
    v_mfma_f32_16x16x32_bf16 v[44:47], v[64:67], v[24:27], 0
    v_mfma_f32_16x16x32_bf16 v[48:51], v[68:71], v[24:27], 0
    v_mfma_f32_16x16x32_bf16 v[52:55], v[72:75], v[24:27], 0
    v_mfma_f32_16x16x32_bf16 v[56:59], v[76:79], v[24:27], 0
    v_and_b32 v28, v35, v8
    v_and_b32 v29, v35, v9
    v_and_b32 v30, v35, v10
    v_and_b32 v31, v35, v11
    s_nop 1
    v_mfma_f32_16x16x32_bf16 v[40:43], v[80:83], v[28:31], v[40:43]
    v_mfma_f32_16x16x32_bf16 v[44:47], v[84:87], v[28:31], v[44:47]
    v_mfma_f32_16x16x32_bf16 v[48:51], v[88:91], v[28:31], v[48:51]
    v_mfma_f32_16x16x32_bf16 v[52:55], v[92:95], v[28:31], v[52:55]
    v_mfma_f32_16x16x32_bf16 v[56:59], v[96:99], v[28:31], v[56:59]
    v_and_b32 v24, v36, v8
    v_and_b32 v25, v36, v9
    v_and_b32 v26, v36, v10
    v_and_b32 v27, v36, v11
    s_nop 1
    v_mfma_f32_16x16x32_bf16 v[40:43], v[100:103], v[24:27], v[40:43]
    v_mfma_f32_16x16x32_bf16 v[44:47], v[104:107], v[24:27], v[44:47]
    v_mfma_f32_16x16x32_bf16 v[48:51], v[108:111], v[24:27], v[48:51]
    v_mfma_f32_16x16x32_bf16 v[52:55], v[112:115], v[24:27], v[52:55]
    v_mfma_f32_16x16x32_bf16 v[56:59], v[116:119], v[24:27], v[56:59]
    v_and_b32 v28, v37, v8
    v_and_b32 v29, v37, v9
    v_and_b32 v30, v37, v10
    v_and_b32 v31, v37, v11
    s_nop 1
    v_mfma_f32_16x16x32_bf16 v[40:43], v[120:123], v[28:31], v[40:43]
    v_mfma_f32_16x16x32_bf16 v[44:47], v[124:127], v[28:31], v[44:47]
    v_mfma_f32_16x16x32_bf16 v[48:51], v[128:131], v[28:31], v[48:51]
    v_mfma_f32_16x16x32_bf16 v[52:55], v[132:135], v[28:31], v[52:55]
    v_mfma_f32_16x16x32_bf16 v[56:59], v[136:139], v[28:31], v[56:59]
    v_and_b32 v24, v38, v8
    v_and_b32 v25, v38, v9
    v_and_b32 v26, v38, v10
    v_and_b32 v27, v38, v11
    s_nop 1
    v_mfma_f32_16x16x32_bf16 v[40:43], v[140:143], v[24:27], v[40:43]
    v_mfma_f32_16x16x32_bf16 v[44:47], v[144:147], v[24:27], v[44:47]
    v_mfma_f32_16x16x32_bf16 v[48:51], v[148:151], v[24:27], v[48:51]
    v_mfma_f32_16x16x32_bf16 v[52:55], v[152:155], v[24:27], v[52:55]
    v_mfma_f32_16x16x32_bf16 v[56:59], v[156:159], v[24:27], v[56:59]
    s_branch L_pp1
L_ppoll:
    s_mov_b64 exec, s[40:41]
    buffer_load_dwordx4 v[252:255], v13, s[68:71], s75 offen sc1
    buffer_load_dwordx4 v[248:251], v12, s[68:71], s74 offen sc1
L_pp1:
    s_waitcnt vmcnt(2)
    v_xor_b32 v240, v6, v240
    v_xor_b32 v241, v6, v241
    v_xor_b32 v242, v6, v242
    v_xor_b32 v243, v6, v243
    v_xor_b32 v244, v6, v244
    v_xor_b32 v245, v6, v245
    v_xor_b32 v246, s81, v246
    v_xor_b32 v247, s81, v247
    v_or3_b32 v32, v240, v241, v242
    v_or3_b32 v33, v243, v244, v245
    v_or_b32 v32, v32, v33
    v_and_b32 v32, 0xff, v32
    v_or3_b32 v32, v32, v246, v247
    v_cmp_eq_u32 vcc, 0, v32
    s_nop 0
    s_mov_b64 exec, vcc
    v_mov_b32 v16, v240
    v_mov_b32 v17, v241
    v_mov_b32 v18, v242
    v_mov_b32 v19, v243
    v_mov_b32 v20, v244
    v_mov_b32 v21, v245
    s_andn2_b64 s[40:41], s[40:41], vcc
    s_cbranch_scc0 L_pdone
    s_mov_b64 exec, s[40:41]
    buffer_load_dwordx4 v[244:247], v13, s[68:71], s75 offen sc1
    buffer_load_dwordx4 v[240:243], v12, s[68:71], s74 offen sc1
    s_waitcnt vmcnt(2)
    v_xor_b32 v248, v6, v248
    v_xor_b32 v249, v6, v249
    v_xor_b32 v250, v6, v250
    v_xor_b32 v251, v6, v251
    v_xor_b32 v252, v6, v252
    v_xor_b32 v253, v6, v253
    v_xor_b32 v254, s81, v254
    v_xor_b32 v255, s81, v255
    v_or3_b32 v32, v248, v249, v250
    v_or3_b32 v33, v251, v252, v253
    v_or_b32 v32, v32, v33
    v_and_b32 v32, 0xff, v32
    v_or3_b32 v32, v32, v254, v255
    v_cmp_eq_u32 vcc, 0, v32
    s_nop 0
    s_mov_b64 exec, vcc
    v_mov_b32 v16, v248
    v_mov_b32 v17, v249
    v_mov_b32 v18, v250
    v_mov_b32 v19, v251
    v_mov_b32 v20, v252
    v_mov_b32 v21, v253
    s_andn2_b64 s[40:41], s[40:41], vcc
    s_cbranch_scc0 L_pdone
    s_sub_u32 s82, s82, 1
    s_cbranch_scc0 L_ppoll
L_pdone:
    s_mov_b64 exec, -1
    s_nop 0
    v_max_f32_dpp v22, v20, v20 quad_perm:[1,0,3,2] row_mask:0xf bank_mask:0xf
    s_nop 1
    v_max_f32_dpp v22, v22, v22 quad_perm:[2,3,0,1] row_mask:0xf bank_mask:0xf
    s_nop 1
    v_max_f32_dpp v22, v22, v22 row_half_mirror row_mask:0xf bank_mask:0xf
    v_sub_f32 v20, v20, v22
    v_mul_f32 v20, s76, v20
    v_exp_f32 v20, v20
    s_nop 0
    v_mul_f32 v21, v21, v20
    v_mul_f32 v16, v16, v20
    v_mul_f32 v17, v17, v20
    v_mul_f32 v18, v18, v20
    v_mul_f32 v19, v19, v20
    v_add_f32_dpp v21, v21, v21 quad_perm:[1,0,3,2] row_mask:0xf bank_mask:0xf
    v_add_f32_dpp v16, v16, v16 quad_perm:[1,0,3,2] row_mask:0xf bank_mask:0xf
    v_add_f32_dpp v17, v17, v17 quad_perm:[1,0,3,2] row_mask:0xf bank_mask:0xf
    v_add_f32_dpp v18, v18, v18 quad_perm:[1,0,3,2] row_mask:0xf bank_mask:0xf
    v_add_f32_dpp v19, v19, v19 quad_perm:[1,0,3,2] row_mask:0xf bank_mask:0xf
    v_add_f32_dpp v21, v21, v21 quad_perm:[2,3,0,1] row_mask:0xf bank_mask:0xf
    v_add_f32_dpp v16, v16, v16 quad_perm:[2,3,0,1] row_mask:0xf bank_mask:0xf
    v_add_f32_dpp v17, v17, v17 quad_perm:[2,3,0,1] row_mask:0xf bank_mask:0xf
    v_add_f32_dpp v18, v18, v18 quad_perm:[2,3,0,1] row_mask:0xf bank_mask:0xf
    v_add_f32_dpp v19, v19, v19 quad_perm:[2,3,0,1] row_mask:0xf bank_mask:0xf
    v_add_f32_dpp v21, v21, v21 row_half_mirror row_mask:0xf bank_mask:0xf
    v_add_f32_dpp v16, v16, v16 row_half_mirror row_mask:0xf bank_mask:0xf
    v_add_f32_dpp v17, v17, v17 row_half_mirror row_mask:0xf bank_mask:0xf
    v_add_f32_dpp v18, v18, v18 row_half_mirror row_mask:0xf bank_mask:0xf
    v_add_f32_dpp v19, v19, v19 row_half_mirror row_mask:0xf bank_mask:0xf
    v_rcp_f32 v21, v21
    s_nop 0
    v_mul_f32 v16, v16, v21
    v_mul_f32 v17, v17, v21
    v_mul_f32 v18, v18, v21
    v_mul_f32 v19, v19, v21
    v_cvt_pk_bf16_f32 v16, v16, v16
    v_cvt_pk_bf16_f32 v17, v17, v17
    v_cvt_pk_bf16_f32 v18, v18, v18
    v_cvt_pk_bf16_f32 v19, v19, v19
    v_and_b32 v24, v16, v8
    v_and_b32 v25, v16, v9
    v_and_b32 v26, v16, v10
    v_and_b32 v27, v16, v11
    v_and_b32 v28, v17, v8
    v_and_b32 v29, v17, v9
    v_and_b32 v30, v17, v10
    v_and_b32 v31, v17, v11
    v_and_b32 v32, v18, v8
    v_and_b32 v33, v18, v9
    v_and_b32 v34, v18, v10
    v_and_b32 v35, v18, v11
    v_and_b32 v36, v19, v8
    v_and_b32 v37, v19, v9
    v_and_b32 v38, v19, v10
    v_and_b32 v39, v19, v11
    v_mfma_f32_16x16x32_bf16 v[40:43], v[160:163], v[24:27], v[40:43]
    v_mfma_f32_16x16x32_bf16 v[40:43], v[180:183], v[28:31], v[40:43]
    v_mfma_f32_16x16x32_bf16 v[40:43], v[200:203], v[32:35], v[40:43]
    v_mfma_f32_16x16x32_bf16 v[40:43], v[220:223], v[36:39], v[40:43]
    v_mfma_f32_16x16x32_bf16 v[44:47], v[164:167], v[24:27], v[44:47]
    v_mfma_f32_16x16x32_bf16 v[44:47], v[184:187], v[28:31], v[44:47]
    v_mfma_f32_16x16x32_bf16 v[44:47], v[204:207], v[32:35], v[44:47]
    v_mfma_f32_16x16x32_bf16 v[44:47], v[224:227], v[36:39], v[44:47]
    v_mfma_f32_16x16x32_bf16 v[48:51], v[168:171], v[24:27], v[48:51]
    v_mfma_f32_16x16x32_bf16 v[48:51], v[188:191], v[28:31], v[48:51]
    v_mfma_f32_16x16x32_bf16 v[48:51], v[208:211], v[32:35], v[48:51]
    v_mfma_f32_16x16x32_bf16 v[48:51], v[228:231], v[36:39], v[48:51]
    v_mfma_f32_16x16x32_bf16 v[52:55], v[172:175], v[24:27], v[52:55]
    v_mfma_f32_16x16x32_bf16 v[52:55], v[192:195], v[28:31], v[52:55]
    v_mfma_f32_16x16x32_bf16 v[52:55], v[212:215], v[32:35], v[52:55]
    v_mfma_f32_16x16x32_bf16 v[52:55], v[232:235], v[36:39], v[52:55]
    v_mfma_f32_16x16x32_bf16 v[56:59], v[176:179], v[24:27], v[56:59]
    v_mfma_f32_16x16x32_bf16 v[56:59], v[196:199], v[28:31], v[56:59]
    v_mfma_f32_16x16x32_bf16 v[56:59], v[216:219], v[32:35], v[56:59]
    v_mfma_f32_16x16x32_bf16 v[56:59], v[236:239], v[36:39], v[56:59]
    s_nop 3
    v_and_or_b32 v40, v40, s85, v6
    v_and_or_b32 v41, v41, s85, v6
    v_and_or_b32 v42, v42, s85, v6
    v_and_or_b32 v43, v43, s85, v6
    buffer_store_dwordx4 v[40:43], v14, s[68:71], s83 offen sc1
    v_and_or_b32 v44, v44, s85, v6
    v_and_or_b32 v45, v45, s85, v6
    v_and_or_b32 v46, v46, s85, v6
    v_and_or_b32 v47, v47, s85, v6
    s_add_u32 s83, s83, 131072
    buffer_store_dwordx4 v[44:47], v14, s[68:71], s83 offen sc1
    v_and_or_b32 v48, v48, s85, v6
    v_and_or_b32 v49, v49, s85, v6
    v_and_or_b32 v50, v50, s85, v6
    v_and_or_b32 v51, v51, s85, v6
    s_add_u32 s83, s83, 131072
    buffer_store_dwordx4 v[48:51], v14, s[68:71], s83 offen sc1
    v_and_or_b32 v52, v52, s85, v6
    v_and_or_b32 v53, v53, s85, v6
    v_and_or_b32 v54, v54, s85, v6
    v_and_or_b32 v55, v55, s85, v6
    s_add_u32 s83, s83, 131072
    buffer_store_dwordx4 v[52:55], v14, s[68:71], s83 offen sc1
    v_and_or_b32 v56, v56, s85, v6
    v_and_or_b32 v57, v57, s85, v6
    v_and_or_b32 v58, v58, s85, v6
    v_and_or_b32 v59, v59, s85, v6
    s_add_u32 s83, s83, 131072
    buffer_store_dwordx4 v[56:59], v15, s[68:71], s83 offen sc1
    s_endpgm
L_exit:
    s_endpgm
.section .rodata,"a"
.p2align 6
.amdhsa_kernel parallel_sum__gqa_block_cached__swiglu_ffn__decode_kernel
  .amdhsa_next_free_vgpr 256
  .amdhsa_next_free_sgpr 100
  .amdhsa_accum_offset 256
  .amdhsa_group_segment_fixed_size 0
  .amdhsa_kernarg_size 96
  .amdhsa_user_sgpr_count 2
  .amdhsa_user_sgpr_kernarg_segment_ptr 1
  .amdhsa_system_sgpr_workgroup_id_x 1
.end_amdhsa_kernel
```
